```python
import torch

def _softmax(x, axis=-1):
    return torch.softmax(x, dim=axis)
def _gelu(x):
    return torch.nn.functional.gelu(x, approximate="tanh")
def _silu(x):
    return torch.nn.functional.silu(x)
def _sigmoid(x):
    return torch.sigmoid(x)
def _layernorm(x, axis=-1, eps=1e-5):
    m = x.mean(dim=axis, keepdim=True)
    v = x.var(dim=axis, keepdim=True, unbiased=False)
    return (x - m) / torch.sqrt(v + eps)
def _scatter_add(tgt, idx, src, axis=0):
    return tgt.clone().index_add_(axis, idx, src)
def _segment_sum(src, seg, n):
    out = torch.zeros((n,) + src.shape[1:], dtype=src.dtype)
    return out.index_add_(0, seg, src)
def _pad(x, pw):
    flat = tuple(v for pair in reversed(pw) for v in pair)
    return torch.nn.functional.pad(x, flat)

kernel_name = 'recurrent_scan__mha_block_cached__glu_gated_reglu__decode'

def setup_inputs():

    _w = (lambda a: (lambda t: t.to(torch.bfloat16) if t.is_floating_point() else t)(torch.as_tensor(a)))
    def _A_setup():
        B, Sq, D = 4, 1, 512
        H, Sk, Dh = 32, 4096, 128
        return {
            "x": _w((lambda *s: torch.randn(*s, dtype=torch.bfloat16) * 0.05)(B, Sq, D)),
            "k_cache": _w((lambda *s: torch.randn(*s, dtype=torch.bfloat16) * 3.2)(B, H, Sk, Dh)),
            "v_cache": _w((lambda *s: torch.randn(*s, dtype=torch.bfloat16) * 3.2)(B, H, Sk, Dh)),
            "wq": _w((lambda *s: torch.randn(*s, dtype=torch.bfloat16) * 3.2)(D, H * Dh) * (D ** -0.5)),
            "wo": _w((lambda *s: torch.randn(*s, dtype=torch.bfloat16) * 3.2)(H * Dh, D) * ((H * Dh) ** -0.5)),
        }
    _A_in = _A_setup()

    def _B_setup():
        B, S, D, F = 4, 1, 512, 1792
        return {
            "x": _w((lambda *s: torch.randn(*s, dtype=torch.bfloat16) * 0.05)(B, S, D)),
            "W_gate": _w((lambda *s: torch.randn(*s, dtype=torch.bfloat16) * 0.4)(D, F) * (2.0 / D) ** 0.5),
            "W_up": _w((lambda *s: torch.randn(*s, dtype=torch.bfloat16) * 0.4)(D, F) * (2.0 / D) ** 0.5),
            "W_down": _w((lambda *s: torch.randn(*s, dtype=torch.bfloat16) * 0.4)(F, D) * (1.0 / F) ** 0.5),
        }
    _B_in = _B_setup()

    return {
        "A_x": _A_in["x"],
        "A_k_cache": _A_in["k_cache"],
        "A_v_cache": _A_in["v_cache"],
        "A_wq": _A_in["wq"],
        "A_wo": _A_in["wo"],
        "B_x": _B_in["x"],
        "B_W_gate": _B_in["W_gate"],
        "B_W_up": _B_in["W_up"],
        "B_W_down": _B_in["W_down"],
    }

def reference(A_x, A_k_cache, A_v_cache, A_wq, A_wo, B_x, B_W_gate, B_W_up, B_W_down):
    def _A_ref(x, k_cache, v_cache, wq, wo):
        B, Sq, D = x.shape
        H, Dh = 32, 128
        q = (lambda x, *d: x.permute(*d))((x @ wq).reshape(B, Sq, H, Dh), 0, 2, 1, 3)
        scores = torch.einsum("bhqd,bhkd->bhqk", q, k_cache) * (Dh ** -0.5)
        p = _softmax(scores, axis=-1)
        o = torch.einsum("bhqk,bhkd->bhqd", p, v_cache)
        return (lambda x, *d: x.permute(*d))(o, 0, 2, 1, 3).reshape(B, Sq, H * Dh) @ wo

    def _B_ref(x, W_gate, W_up, W_down):
        gate = torch.einsum("bsd,df->bsf", x, W_gate)
        up = torch.einsum("bsd,df->bsf", x, W_up)
        gate = gate * (lambda x, dt: x.to(dt))(gate > 0, gate.dtype)
        h = gate * up
        return torch.einsum("bsf,fd->bsd", h, W_down)

    x = A_x
    xn = _layernorm(x, axis=-1)
    s = _A_ref(xn, A_k_cache, A_v_cache, A_wq, A_wo)
    g = _silu(_B_ref(xn, B_W_gate, B_W_up, B_W_down))
    return x + s * g
```

```asm
; @launch grid=(256,1,1) block=(512,1,1) lds=112128
.amdgcn_target "amdgcn-amd-amdhsa--gfx950"
.text
.globl recurrent_scan__mha_block_cached__glu_gated_reglu__decode_kernel
.p2align 8
.type recurrent_scan__mha_block_cached__glu_gated_reglu__decode_kernel,@function
recurrent_scan__mha_block_cached__glu_gated_reglu__decode_kernel:
    s_cmp_ge_u32 s2, 256
    s_cbranch_scc1 L_end
    s_load_dwordx8 s[4:11], s[0:1], 0
    s_load_dwordx2 s[12:13], s[0:1], 32
    s_load_dwordx8 s[16:23], s[0:1], 48
    s_load_dwordx2 s[26:27], s[0:1], 88
    v_lshrrev_b32 v1, 6, v0
    v_and_b32 v0, 63, v0
    v_readfirstlane_b32 s3, v1
    s_and_b32 s67, s2, 7
    s_lshr_b32 s66, s2, 3
    s_and_b32 s28, s66, 24
    s_add_u32 s28, s28, s67
    s_bfe_u32 s29, s2, 0x20004
    s_and_b32 s14, s66, 7
    s_and_b32 s30, s14, 1
    s_lshl_b32 s31, s29, 5
    s_add_u32 s31, s31, s28
    v_and_b32 v50, 15, v0
    v_lshrrev_b32 v51, 4, v0
    v_lshlrev_b32 v2, 4, v0
    s_mov_b32 s39, 0x20000
    s_mov_b32 s43, 0x20000
    s_mov_b32 s42, 0x100000
    s_cmp_ge_u32 s3, 4
    s_cbranch_scc1 L_hpro
    v_lshrrev_b32 v53, 2, v50
    v_lshlrev_b32 v1, 8, v53
    v_lshl_add_u32 v1, v51, 6, v1
    v_and_b32 v3, 3, v0
    v_lshl_add_u32 v1, v3, 4, v1
    s_lshl_b32 s31, s31, 20
    s_lshl3_add_u32 s44, s30, s3
    s_lshl_b32 s44, s44, 12
    s_mov_b32 s45, s44
    s_mul_i32 s35, s3, 24576
    s_add_u32 s35, s35, 13824
    s_mov_b32 s38, 0x100000
    s_waitcnt lgkmcnt(0)
    s_add_u32 s36, s6, s31
    s_addc_u32 s37, s7, 0
    s_add_u32 m0, s35, 0
    s_nop 0
    buffer_load_dwordx4 v1, s[36:39], s44 offen offset:0 nt lds
    buffer_load_dwordx4 v1, s[36:39], s44 offen offset:1024 nt lds
    buffer_load_dwordx4 v1, s[36:39], s44 offen offset:2048 nt lds
    buffer_load_dwordx4 v1, s[36:39], s44 offen offset:3072 nt lds
    s_add_u32 s44, s44, 16384
    s_add_u32 m0, s35, 4096
    s_nop 0
    buffer_load_dwordx4 v1, s[36:39], s44 offen offset:0 nt lds
    s_load_dword s24, s[16:17], 0
    s_load_dword s24, s[18:19], 0
    s_load_dword s24, s[20:21], 0
    s_lshl_b32 s25, s28, 17
    s_load_dword s24, s[12:13], s25
    s_branch L_stream
L_hpro:
    s_setprio 1
    s_sub_u32 s3, s3, 4
    v_lshlrev_b32 v1, 13, v51
    v_lshl_add_u32 v1, v50, 4, v1
    v_mov_b32 v44, 0xbf800000
    v_lshlrev_b32 v45, 2, v0
    ds_write_b32 v45, v44 offset:3328
    s_lshl_b32 s44, s3, 20
    s_lshl_b32 s45, s28, 8
    s_add_u32 s35, s44, s45
    s_lshl_b32 s44, s14, 17
    s_lshl_b32 s46, s3, 10
    s_mov_b32 s38, 4096
    s_waitcnt lgkmcnt(0)
    s_add_u32 s40, s10, s35
    s_addc_u32 s41, s11, 0
    s_mov_b32 s36, s4
    s_mov_b32 s37, s5
    buffer_load_dwordx4 v[64:67], v1, s[40:43], s44 offen
    s_add_u32 s44, s44, 0x8000
    buffer_load_dwordx4 v[68:71], v1, s[40:43], s44 offen
    s_add_u32 s44, s44, 0x8000
    buffer_load_dwordx4 v[16:19], v2, s[36:39], s46 offen
    s_load_dword s70, s[26:27], 819200
    s_barrier
    s_branch L_helper
L_stream:
    s_load_dword s70, s[26:27], 819200
    s_barrier
    s_lshl_b32 s25, s2, 7
    s_add_u32 s25, s25, 852028
    s_load_dwordx2 s[24:25], s[26:27], s25
    s_add_u32 s40, s8, s31
    s_addc_u32 s41, s9, 0
    v_mov_b32 v63, 0
    v_lshrrev_b32 v52, 3, v0
    v_mul_u32_u24 v52, 3584, v52
    v_and_b32 v53, 7, v0
    v_lshl_add_u32 v48, v53, 4, v52
    s_lshl_b32 s32, s67, 2
    s_lshr_b32 s67, 0x54326100, s32
    s_and_b32 s67, s67, 15
    s_lshr_b32 s33, s66, 3
    s_lshl2_add_u32 s32, s67, s33
    s_mul_i32 s33, s32, 86
    s_lshr_b32 s33, s33, 8
    s_add_u32 s33, s33, s32
    s_lshl_b32 s15, s32, 2
    s_sub_u32 s15, s15, 81
    s_cmp_lt_u32 s32, 21
    s_cselect_b32 s32, s33, s15
    s_lshl3_add_u32 s62, s32, s14
    s_lshl2_add_u32 s62, s62, s3
    s_lshl_b32 s62, s62, 11
    s_lshl_b32 s32, s32, 7
    s_lshl_b32 s33, s14, 1
    s_and_b32 s46, s3, 1
    s_add_u32 s33, s33, s46
    s_mul_i32 s33, s33, 114688
    s_add_u32 s60, s32, s33
    s_lshl_b32 s61, s28, 5
    s_lshl_b32 s33, s14, 2
    s_add_u32 s61, s61, s33
    s_add_u32 s61, s61, s3
    s_lshl_b32 s61, s61, 12
    s_and_b32 s32, s2, 7
    s_cmp_eq_u32 s32, 0
    s_cselect_b32 s32, 0x200000, 0
    v_add_u32 v48, s32, v48
    v_add_u32 v49, s32, v2
    s_cmp_lt_u32 s3, 2
    s_cselect_b32 s48, s16, s18
    s_cselect_b32 s49, s17, s19
    s_mov_b32 s50, 1835008
    s_mov_b32 s51, 0x20000
    s_mov_b32 s52, s12
    s_mov_b32 s53, s13
    s_mov_b32 s54, 4194304
    s_mov_b32 s55, 0x20000
    s_mov_b32 s56, s20
    s_mov_b32 s57, s21
    s_mov_b32 s58, 1835008
    s_mov_b32 s59, 0x20000
    s_waitcnt vmcnt(4)
    buffer_load_dwordx4 v[44:47], v48, s[48:51], s60 offen
    s_add_u32 s60, s60, 28672
    s_waitcnt vmcnt(4)
    buffer_load_dwordx4 v[44:47], v48, s[48:51], s60 offen
    s_add_u32 s60, s60, 28672
    s_waitcnt vmcnt(4)
    buffer_load_dwordx4 v[44:47], v48, s[48:51], s60 offen
    s_add_u32 s60, s60, 28672
    s_waitcnt vmcnt(4)
    buffer_load_dwordx4 v[44:47], v48, s[48:51], s60 offen
    s_waitcnt vmcnt(4)
    buffer_load_dwordx4 v[44:47], v49, s[56:59], s62 offen offset:0
    s_waitcnt vmcnt(4)
    buffer_load_dwordx4 v[44:47], v49, s[56:59], s62 offen offset:1024
    s_waitcnt vmcnt(4)
    buffer_load_dwordx4 v[44:47], v2, s[52:55], s61 offen offset:0
    s_waitcnt vmcnt(4)
    buffer_load_dwordx4 v[44:47], v2, s[52:55], s61 offen offset:1024
    s_waitcnt vmcnt(4)
    buffer_load_dwordx4 v[44:47], v2, s[52:55], s61 offen offset:2048
    s_waitcnt vmcnt(4)
    buffer_load_dwordx4 v[44:47], v2, s[52:55], s61 offen offset:3072
    s_waitcnt vmcnt(4)
    buffer_load_dwordx4 v1, s[36:39], s44 offen offset:1024 nt lds
    s_waitcnt vmcnt(4)
    buffer_load_dwordx4 v1, s[36:39], s44 offen offset:2048 nt lds
    v_and_b32 v52, 1, v0
    v_mov_b32 v53, 0xffff
    v_mov_b32 v54, 0xffff0000
    v_cmp_eq_u32 vcc, 1, v52
    v_bfe_u32 v52, v0, 1, 2
    s_nop 0
    v_cndmask_b32 v53, v53, v54, vcc
    v_cmp_eq_u32 vcc, 0, v52
    s_nop 1
    v_cndmask_b32 v4, 0, v53, vcc
    v_cmp_eq_u32 vcc, 1, v52
    s_nop 1
    v_cndmask_b32 v5, 0, v53, vcc
    v_cmp_eq_u32 vcc, 2, v52
    s_nop 1
    v_cndmask_b32 v6, 0, v53, vcc
    v_cmp_eq_u32 vcc, 3, v52
    s_nop 1
    v_cndmask_b32 v7, 0, v53, vcc
    v_lshrrev_b32 v53, 2, v50
    v_lshl_add_u32 v52, v51, 2, v3
    v_lshlrev_b32 v52, 5, v52
    v_lshlrev_b32 v3, 2, v3
    v_add_u32 v61, s35, v2
    s_waitcnt vmcnt(4)
    buffer_load_dwordx4 v1, s[36:39], s44 offen offset:3072 nt lds
    s_add_u32 s44, s44, 49152
    s_waitcnt vmcnt(4)
    s_add_u32 m0, s35, 8192
    s_nop 0
    buffer_load_dwordx4 v1, s[36:39], s44 offen offset:0 nt lds
    s_bfe_u32 s34, s2, 0x20001
    s_and_b32 s15, s2, 1
    s_lshl_b32 s15, s15, 2
    s_and_b32 s32, s14, 3
    s_add_u32 s15, s15, s32
    s_lshr_b32 s32, s14, 2
    s_lshl_b32 s46, s15, 5
    s_lshl_b32 s47, s32, 3
    s_add_u32 s46, s46, s47
    s_lshl_b32 s47, s34, 8
    s_add_u32 s46, s46, s47
    s_lshr_b32 s33, s2, 6
    s_lshl_b32 s47, s33, 10
    s_add_u32 s46, s46, s47
    s_lshl_b32 s15, s15, 5
    s_lshl_b32 s32, s32, 8
    s_add_u32 s15, s15, s32
    v_and_b32 v55, 1, v0
    v_lshrrev_b32 v58, 1, v0
    v_lshlrev_b32 v58, 11, v58
    v_lshl_add_u32 v58, v55, 4, v58
    v_lshl_add_u32 v55, v55, 4, s46
    v_bfe_u32 v54, v0, 4, 1
    v_lshl_add_u32 v55, v54, 2, v55
    v_lshrrev_b32 v54, 5, v0
    v_lshl_add_u32 v55, v54, 1, v55
    s_lshl_b32 s46, s33, 17
    s_lshl_b32 s47, s34, 9
    s_add_u32 s46, s46, s47
    s_add_u32 s46, s46, s15
    s_add_u32 s47, s46, 0x10000
    s_mul_i32 s34, s34, 57344
    s_lshl_b32 s33, s33, 9
    s_add_u32 s34, s34, s33
    s_add_u32 s34, s34, s15
    s_add_u32 s34, s34, 524288
    s_waitcnt vmcnt(4)
    buffer_load_dwordx4 v1, s[36:39], s44 offen offset:1024 nt lds
    s_waitcnt vmcnt(4)
    buffer_load_dwordx4 v1, s[36:39], s44 offen offset:2048 nt lds
    s_mov_b32 s48, s26
    s_mov_b32 s49, s27
    s_mov_b32 s50, 1048576
    s_mov_b32 s51, 0x20000
    s_mov_b32 s52, s4
    s_mov_b32 s53, s5
    s_mov_b32 s54, 4096
    s_mov_b32 s55, 0x20000
    s_mov_b32 s56, s22
    s_mov_b32 s57, s23
    s_mov_b32 s58, 4096
    s_mov_b32 s59, 0x20000
    s_waitcnt lgkmcnt(0)
    s_add_u32 s70, s70, 1
    s_and_b32 s70, s70, 0xff
    v_mov_b32 v62, s70
    s_mov_b32 s93, 0
    s_and_b32 s32, s2, 7
    s_lshl_b32 s32, s32, 2
    s_lshr_b32 s95, 0x48884888, s32
    s_and_b32 s95, s95, 15
    s_sub_i32 s95, s95, 8
    s_mul_i32 s95, s95, 4
    s_and_b32 s32, s2, 7
    s_lshl_b32 s32, s32, 7
    v_lshl_add_u32 v48, v0, 2, s32
    v_mov_b32 v49, 1048576
    v_cmp_gt_u32 vcc, 32, v0
    s_nop 1
    v_cndmask_b32 v48, v49, v48, vcc
    s_xor_b32 s33, s3, 0
    s_lshr_b32 s15, s66, 2
    s_xor_b32 s15, s15, s66
    s_and_b32 s15, s15, 0
    s_or_b32 s33, s33, s15
    s_lshl_b32 s33, s33, 6
    s_add_u32 s33, s33, s66
    v_cmp_eq_u32 vcc, s33, v0
    s_nop 1
    v_cndmask_b32 v49, v49, v48, vcc
    s_or_b32 s71, s70, 0x5a3c9600
    v_mov_b32 v60, s71
    s_mov_b32 s64, 0x22222222
    s_mov_b32 s65, 0x22222222
    s_mov_b32 s66, 0x44444444
    s_mov_b32 s67, 0x44444444
    s_mov_b32 s68, 0x88888888
    s_mov_b32 s69, 0x88888888
    s_mov_b32 s60, 0x00030003
    s_mov_b32 s61, 0x00030003
    s_waitcnt vmcnt(4)
    buffer_load_dwordx4 v1, s[36:39], s44 offen offset:3072 nt lds
    s_add_u32 s44, s44, 16384
    s_waitcnt vmcnt(4)
    s_add_u32 m0, s35, 12288
    s_nop 0
    buffer_load_dwordx4 v1, s[36:39], s44 offen offset:0 nt lds
    s_waitcnt vmcnt(4)
    buffer_load_dwordx4 v1, s[36:39], s44 offen offset:1024 nt lds
    s_waitcnt vmcnt(4)
    buffer_load_dwordx4 v1, s[36:39], s44 offen offset:2048 nt lds
    s_waitcnt vmcnt(4)
    buffer_load_dwordx4 v1, s[36:39], s44 offen offset:3072 nt lds
    s_add_u32 s44, s44, 49152
    s_waitcnt vmcnt(4)
    s_add_u32 m0, s35, 16384
    s_nop 0
    buffer_load_dwordx4 v1, s[36:39], s44 offen offset:0 nt lds
    s_waitcnt vmcnt(4)
    buffer_load_dwordx4 v1, s[36:39], s44 offen offset:1024 nt lds
    s_waitcnt vmcnt(4)
    buffer_load_dwordx4 v1, s[36:39], s44 offen offset:2048 nt lds
    s_waitcnt vmcnt(4)
    buffer_load_dwordx4 v1, s[36:39], s44 offen offset:3072 nt lds
    s_add_u32 s44, s44, 16384
    s_waitcnt vmcnt(4)
    s_add_u32 m0, s35, 20480
    s_nop 0
    buffer_load_dwordx4 v1, s[36:39], s44 offen offset:0 nt lds
    s_waitcnt vmcnt(4)
    buffer_load_dwordx4 v1, s[36:39], s44 offen offset:1024 nt lds
    s_waitcnt vmcnt(4)
    buffer_load_dwordx4 v1, s[36:39], s44 offen offset:2048 nt lds
    s_waitcnt vmcnt(4)
    buffer_load_dwordx4 v1, s[36:39], s44 offen offset:3072 nt lds
    s_add_u32 s44, s44, 49152
    s_waitcnt vmcnt(4)
    buffer_load_dwordx4 v[64:67], v1, s[36:39], s44 offen offset:0 nt
    s_waitcnt vmcnt(4)
    buffer_load_dwordx4 v[68:71], v1, s[36:39], s44 offen offset:1024 nt
    s_waitcnt vmcnt(4)
    buffer_load_dwordx4 v[72:75], v1, s[36:39], s44 offen offset:2048 nt
    s_waitcnt vmcnt(4)
    buffer_load_dwordx4 v[76:79], v1, s[36:39], s44 offen offset:3072 nt
    s_add_u32 s44, s44, 16384
    s_waitcnt vmcnt(4)
    buffer_load_dwordx4 v[80:83], v1, s[36:39], s44 offen offset:0 nt
    s_waitcnt vmcnt(4)
    buffer_load_dwordx4 v[84:87], v1, s[36:39], s44 offen offset:1024 nt
    s_waitcnt vmcnt(4)
    buffer_load_dwordx4 v[88:91], v1, s[36:39], s44 offen offset:2048 nt
    s_mov_b32 s32, 851968
    buffer_load_dword v54, v48, s[48:51], s32 offen nt
    s_waitcnt vmcnt(5)
    buffer_load_dwordx4 v[92:95], v1, s[36:39], s44 offen offset:3072 nt
    s_add_u32 s44, s44, 49152
    s_waitcnt vmcnt(5)
    buffer_load_dwordx4 v[96:99], v1, s[36:39], s44 offen offset:0 nt
    s_mov_b32 s32, 851968
    buffer_store_dword v60, v49, s[48:51], s32 offen
    s_waitcnt vmcnt(6)
    buffer_load_dwordx4 v[100:103], v1, s[36:39], s44 offen offset:1024 nt
    s_waitcnt vmcnt(6)
    buffer_load_dwordx4 v[104:107], v1, s[36:39], s44 offen offset:2048 nt
    s_waitcnt vmcnt(6)
    buffer_load_dwordx4 v[108:111], v1, s[36:39], s44 offen offset:3072 nt
    s_add_u32 s44, s44, 16384
    s_waitcnt vmcnt(5)
    buffer_load_dwordx4 v[112:115], v1, s[36:39], s44 offen offset:0 nt
    s_waitcnt vmcnt(5)
    buffer_load_dwordx4 v[116:119], v1, s[36:39], s44 offen offset:1024 nt
    s_waitcnt vmcnt(4)
    buffer_load_dwordx4 v[120:123], v1, s[36:39], s44 offen offset:2048 nt
    s_waitcnt vmcnt(4)
    buffer_load_dwordx4 v[124:127], v1, s[36:39], s44 offen offset:3072 nt
    s_add_u32 s44, s44, 49152
    v_cmp_eq_u32 vcc, v60, v54
    s_nop 0
    s_bcnt1_i32_b64 s93, vcc
    s_cmp_ge_u32 s93, 16
    s_cbranch_scc1 L_d40
    s_waitcnt vmcnt(4)
L_d40:
    buffer_load_dwordx4 v[128:131], v1, s[36:39], s44 offen offset:0 nt
    s_waitcnt vmcnt(5)
    s_cmp_ge_u32 s93, 16
    s_cbranch_scc1 L_d41
    s_waitcnt vmcnt(4)
L_d41:
    buffer_load_dwordx4 v[132:135], v1, s[36:39], s44 offen offset:1024 nt
    s_waitcnt vmcnt(5)
    s_cmp_ge_u32 s93, 16
    s_cbranch_scc1 L_d42
    s_waitcnt vmcnt(4)
L_d42:
    buffer_load_dwordx4 v[136:139], v1, s[36:39], s44 offen offset:2048 nt
    s_waitcnt vmcnt(5)
    s_cmp_ge_u32 s93, 16
    s_cbranch_scc1 L_d43
    s_waitcnt vmcnt(4)
L_d43:
    buffer_load_dwordx4 v[140:143], v1, s[36:39], s44 offen offset:3072 nt
    s_add_u32 s44, s44, 16384
    s_waitcnt vmcnt(5)
    s_cmp_ge_u32 s93, 16
    s_cbranch_scc1 L_d44
    s_waitcnt vmcnt(4)
L_d44:
    buffer_load_dwordx4 v[144:147], v1, s[36:39], s44 offen offset:0 nt
    s_waitcnt vmcnt(5)
    s_cmp_ge_u32 s93, 16
    s_cbranch_scc1 L_d45
    s_waitcnt vmcnt(4)
L_d45:
    buffer_load_dwordx4 v[148:151], v1, s[36:39], s44 offen offset:1024 nt
    s_waitcnt vmcnt(5)
    s_cmp_ge_u32 s93, 16
    s_cbranch_scc1 L_d46
    s_waitcnt vmcnt(4)
L_d46:
    buffer_load_dwordx4 v[152:155], v1, s[36:39], s44 offen offset:2048 nt
    s_mov_b32 s32, 852992
    buffer_load_dword v47, v48, s[48:51], s32 offen nt
    s_waitcnt vmcnt(6)
    s_cmp_ge_u32 s93, 16
    s_cbranch_scc1 L_d47
    s_waitcnt vmcnt(5)
L_d47:
    buffer_load_dwordx4 v[156:159], v1, s[36:39], s44 offen offset:3072 nt
    s_add_u32 s44, s44, 49152
    s_waitcnt vmcnt(6)
    s_cmp_ge_u32 s93, 16
    s_cbranch_scc1 L_d48
    s_waitcnt vmcnt(5)
L_d48:
    buffer_load_dwordx4 v[160:163], v1, s[36:39], s44 offen offset:0 nt
    s_mov_b32 s32, 852992
    buffer_store_dword v60, v49, s[48:51], s32 offen
    s_waitcnt vmcnt(7)
    s_cmp_ge_u32 s93, 16
    s_cbranch_scc1 L_d49
    s_waitcnt vmcnt(6)
L_d49:
    buffer_load_dwordx4 v[164:167], v1, s[36:39], s44 offen offset:1024 nt
    s_waitcnt vmcnt(7)
    s_cmp_ge_u32 s93, 16
    s_cbranch_scc1 L_d50
    s_waitcnt vmcnt(6)
L_d50:
    buffer_load_dwordx4 v[168:171], v1, s[36:39], s44 offen offset:2048 nt
    s_waitcnt vmcnt(7)
    s_cmp_ge_u32 s93, 16
    s_cbranch_scc1 L_d51
    s_waitcnt vmcnt(6)
    s_cmp_lt_i32 s95, -12
    s_cbranch_scc0 L_d51
    s_waitcnt vmcnt(4)
L_d51:
    buffer_load_dwordx4 v[172:175], v1, s[36:39], s44 offen offset:3072 nt
    s_add_u32 s44, s44, 16384
    s_waitcnt vmcnt(7)
    s_cmp_ge_u32 s93, 16
    s_cbranch_scc1 L_d52
    s_waitcnt vmcnt(5)
L_d52:
    buffer_load_dwordx4 v[176:179], v1, s[36:39], s44 offen offset:0 nt
    s_waitcnt vmcnt(6)
    s_cmp_ge_u32 s93, 16
    s_cbranch_scc1 L_d53
    s_waitcnt vmcnt(5)
L_d53:
    buffer_load_dwordx4 v[180:183], v1, s[36:39], s44 offen offset:1024 nt
    s_waitcnt vmcnt(6)
    s_cmp_ge_u32 s93, 16
    s_cbranch_scc1 L_d54
    s_waitcnt vmcnt(4)
L_d54:
    buffer_load_dwordx4 v[184:187], v1, s[36:39], s44 offen offset:2048 nt
    s_waitcnt vmcnt(5)
    s_cmp_ge_u32 s93, 16
    s_cbranch_scc1 L_d55
    s_waitcnt vmcnt(4)
L_d55:
    buffer_load_dwordx4 v[188:191], v1, s[36:39], s44 offen offset:3072 nt
    s_add_u32 s44, s44, 49152
    v_cmp_eq_u32 vcc, v60, v47
    s_nop 0
    s_bcnt1_i32_b64 s93, vcc
    s_waitcnt vmcnt(5)
    s_cmp_ge_u32 s93, 16
    s_cbranch_scc1 L_d56
    s_waitcnt vmcnt(4)
L_d56:
    buffer_load_dwordx4 v[192:195], v1, s[36:39], s44 offen offset:0 nt
    s_waitcnt vmcnt(5)
    s_cmp_ge_u32 s93, 16
    s_cbranch_scc1 L_d57
    s_waitcnt vmcnt(4)
L_d57:
    buffer_load_dwordx4 v[196:199], v1, s[36:39], s44 offen offset:1024 nt
    s_waitcnt vmcnt(5)
    s_cmp_ge_u32 s93, 16
    s_cbranch_scc1 L_d58
    s_waitcnt vmcnt(4)
L_d58:
    buffer_load_dwordx4 v[200:203], v1, s[36:39], s44 offen offset:2048 nt
    s_waitcnt vmcnt(5)
    s_cmp_ge_u32 s93, 16
    s_cbranch_scc1 L_d59
    s_waitcnt vmcnt(4)
L_d59:
    buffer_load_dwordx4 v[204:207], v1, s[36:39], s44 offen offset:3072 nt
    s_add_u32 s44, s44, 16384
    s_waitcnt vmcnt(5)
    s_cmp_ge_u32 s93, 16
    s_cbranch_scc1 L_d60
    s_waitcnt vmcnt(4)
L_d60:
    buffer_load_dwordx4 v[208:211], v1, s[36:39], s44 offen offset:0 nt
    s_waitcnt vmcnt(5)
    s_cmp_ge_u32 s93, 16
    s_cbranch_scc1 L_d61
    s_waitcnt vmcnt(4)
L_d61:
    buffer_load_dwordx4 v[212:215], v1, s[36:39], s44 offen offset:1024 nt
    s_mov_b32 s33, 1000000
L_qf:
    ds_read_b32 v59, v3 offset:3360
    s_waitcnt lgkmcnt(0)
    v_cmp_eq_u32 vcc, 0xbf800000, v59
    s_cbranch_vccz L_qf_ok
    s_sleep 1
    s_sub_u32 s33, s33, 1
    s_cmp_lg_u32 s33, 0
    s_cbranch_scc1 L_qf
L_qf_ok:
    ds_read_b128 v[8:11], v52 offset:0
    ds_read_b128 v[12:15], v52 offset:16
    ds_read_b128 v[16:19], v52 offset:512
    ds_read_b128 v[20:23], v52 offset:528
    ds_read_b128 v[24:27], v52 offset:1024
    ds_read_b128 v[28:31], v52 offset:1040
    ds_read_b128 v[32:35], v52 offset:1536
    ds_read_b128 v[36:39], v52 offset:1552
    s_waitcnt vmcnt(5)
    s_cmp_ge_u32 s93, 16
    s_cbranch_scc1 L_d62
    s_waitcnt vmcnt(4)
L_d62:
    buffer_load_dwordx4 v[216:219], v1, s[36:39], s44 offen offset:2048 nt
    s_mov_b32 s32, 854016
    buffer_load_dword v54, v48, s[48:51], s32 offen nt
    s_waitcnt lgkmcnt(0)
    v_pk_add_f32 v[8:9], v[8:9], v[16:17]
    v_pk_add_f32 v[24:25], v[24:25], v[32:33]
    v_pk_add_f32 v[10:11], v[10:11], v[18:19]
    v_pk_add_f32 v[26:27], v[26:27], v[34:35]
    v_pk_add_f32 v[12:13], v[12:13], v[20:21]
    v_pk_add_f32 v[28:29], v[28:29], v[36:37]
    v_pk_add_f32 v[14:15], v[14:15], v[22:23]
    v_pk_add_f32 v[30:31], v[30:31], v[38:39]
    v_pk_add_f32 v[24:25], v[24:25], v[8:9]
    v_pk_add_f32 v[26:27], v[26:27], v[10:11]
    v_pk_add_f32 v[28:29], v[28:29], v[12:13]
    v_pk_add_f32 v[30:31], v[30:31], v[14:15]
    v_cvt_pk_bf16_f32 v40, v24, v25
    v_cvt_pk_bf16_f32 v41, v26, v27
    v_cvt_pk_bf16_f32 v42, v28, v29
    v_cvt_pk_bf16_f32 v43, v30, v31
    s_waitcnt vmcnt(6)
    s_cmp_ge_u32 s93, 16
    s_cbranch_scc1 L_d63
    s_waitcnt vmcnt(5)
L_d63:
    buffer_load_dwordx4 v[220:223], v1, s[36:39], s44 offen offset:3072 nt
    s_add_u32 s44, s44, 49152
    v_cmp_eq_u32 vcc, 0, v53
    s_nop 1
    v_cndmask_b32 v8, 0, v40, vcc
    v_cndmask_b32 v9, 0, v41, vcc
    v_cndmask_b32 v10, 0, v42, vcc
    v_cndmask_b32 v11, 0, v43, vcc
    v_cmp_eq_u32 vcc, 1, v53
    s_nop 1
    v_cndmask_b32 v12, 0, v40, vcc
    v_cndmask_b32 v13, 0, v41, vcc
    v_cndmask_b32 v14, 0, v42, vcc
    v_cndmask_b32 v15, 0, v43, vcc
    v_cmp_eq_u32 vcc, 2, v53
    s_nop 1
    v_cndmask_b32 v16, 0, v40, vcc
    v_cndmask_b32 v17, 0, v41, vcc
    v_cndmask_b32 v18, 0, v42, vcc
    v_cndmask_b32 v19, 0, v43, vcc
    v_cmp_eq_u32 vcc, 3, v53
    s_nop 1
    v_cndmask_b32 v20, 0, v40, vcc
    v_cndmask_b32 v21, 0, v41, vcc
    v_cndmask_b32 v22, 0, v42, vcc
    v_cndmask_b32 v23, 0, v43, vcc
    ds_read_b128 v[32:35], v61
    s_waitcnt vmcnt(6)
    s_cmp_ge_u32 s93, 16
    s_cbranch_scc1 L_d64
    s_waitcnt vmcnt(5)
L_d64:
    buffer_load_dwordx4 v[224:227], v1, s[36:39], s44 offen offset:0 nt
    s_mov_b32 s32, 854016
    buffer_store_dword v60, v49, s[48:51], s32 offen
    ds_read_b128 v[40:43], v61 offset:1024
    s_waitcnt lgkmcnt(1)
    v_mfma_f32_16x16x32_bf16 v[24:27], v[32:35], v[8:11], 0
    ds_read_b128 v[32:35], v61 offset:2048
    s_waitcnt lgkmcnt(1)
    v_mfma_f32_16x16x32_bf16 v[24:27], v[40:43], v[12:15], v[24:27]
    ds_read_b128 v[40:43], v61 offset:3072
    s_waitcnt lgkmcnt(1)
    v_mfma_f32_16x16x32_bf16 v[24:27], v[32:35], v[16:19], v[24:27]
    ds_read_b128 v[32:35], v61 offset:4096
    s_waitcnt lgkmcnt(1)
    v_mfma_f32_16x16x32_bf16 v[24:27], v[40:43], v[20:23], v[24:27]
    ds_read_b128 v[40:43], v61 offset:5120
    s_waitcnt lgkmcnt(1)
    v_mfma_f32_16x16x32_bf16 v[28:31], v[32:35], v[8:11], 0
    ds_read_b128 v[32:35], v61 offset:6144
    s_waitcnt lgkmcnt(1)
    v_mfma_f32_16x16x32_bf16 v[28:31], v[40:43], v[12:15], v[28:31]
    s_nop 1
    v_mov_b32_dpp v44, v24 quad_perm:[0,0,0,0] row_mask:0xf bank_mask:0xf
    v_mov_b32_dpp v45, v26 quad_perm:[2,2,2,2] row_mask:0xf bank_mask:0xf
    s_nop 0
    v_add_f32_dpp v44, v25, v44 quad_perm:[1,1,1,1] row_mask:0xf bank_mask:0xf
    v_add_f32_dpp v45, v27, v45 quad_perm:[3,3,3,3] row_mask:0xf bank_mask:0xf
    v_add_f32 v36, v44, v45
    s_waitcnt vmcnt(7)
    s_cmp_ge_u32 s93, 16
    s_cbranch_scc1 L_d65
    s_waitcnt vmcnt(6)
L_d65:
    buffer_load_dwordx4 v[228:231], v1, s[36:39], s44 offen offset:1024 nt
    ds_read_b128 v[40:43], v61 offset:7168
    s_waitcnt lgkmcnt(1)
    v_mfma_f32_16x16x32_bf16 v[28:31], v[32:35], v[16:19], v[28:31]
    ds_read_b128 v[32:35], v61 offset:8192
    s_waitcnt lgkmcnt(1)
    v_mfma_f32_16x16x32_bf16 v[28:31], v[40:43], v[20:23], v[28:31]
    ds_read_b128 v[40:43], v61 offset:9216
    s_waitcnt lgkmcnt(1)
    v_mfma_f32_16x16x32_bf16 v[24:27], v[32:35], v[8:11], 0
    ds_read_b128 v[32:35], v61 offset:10240
    s_waitcnt lgkmcnt(1)
    v_mfma_f32_16x16x32_bf16 v[24:27], v[40:43], v[12:15], v[24:27]
    s_nop 1
    v_mov_b32_dpp v44, v28 quad_perm:[0,0,0,0] row_mask:0xf bank_mask:0xf
    v_mov_b32_dpp v45, v30 quad_perm:[2,2,2,2] row_mask:0xf bank_mask:0xf
    s_nop 0
    v_add_f32_dpp v44, v29, v44 quad_perm:[1,1,1,1] row_mask:0xf bank_mask:0xf
    v_add_f32_dpp v45, v31, v45 quad_perm:[3,3,3,3] row_mask:0xf bank_mask:0xf
    v_add_f32 v44, v44, v45
    v_cndmask_b32 v36, v36, v44, s[64:65]
    s_waitcnt vmcnt(7)
    s_cmp_ge_u32 s93, 16
    s_cbranch_scc1 L_d66
    s_waitcnt vmcnt(6)
L_d66:
    buffer_load_dwordx4 v[232:235], v1, s[36:39], s44 offen offset:2048 nt
    ds_read_b128 v[40:43], v61 offset:11264
    s_waitcnt lgkmcnt(1)
    v_mfma_f32_16x16x32_bf16 v[24:27], v[32:35], v[16:19], v[24:27]
    ds_read_b128 v[32:35], v61 offset:12288
    s_waitcnt lgkmcnt(1)
    v_mfma_f32_16x16x32_bf16 v[24:27], v[40:43], v[20:23], v[24:27]
    ds_read_b128 v[40:43], v61 offset:13312
    s_waitcnt lgkmcnt(1)
    v_mfma_f32_16x16x32_bf16 v[28:31], v[32:35], v[8:11], 0
    ds_read_b128 v[32:35], v61 offset:14336
    s_waitcnt lgkmcnt(1)
    v_mfma_f32_16x16x32_bf16 v[28:31], v[40:43], v[12:15], v[28:31]
    s_nop 1
    v_mov_b32_dpp v44, v24 quad_perm:[0,0,0,0] row_mask:0xf bank_mask:0xf
    v_mov_b32_dpp v45, v26 quad_perm:[2,2,2,2] row_mask:0xf bank_mask:0xf
    s_nop 0
    v_add_f32_dpp v44, v25, v44 quad_perm:[1,1,1,1] row_mask:0xf bank_mask:0xf
    v_add_f32_dpp v45, v27, v45 quad_perm:[3,3,3,3] row_mask:0xf bank_mask:0xf
    v_add_f32 v44, v44, v45
    v_cndmask_b32 v36, v36, v44, s[66:67]
    s_waitcnt vmcnt(7)
    s_cmp_ge_u32 s93, 16
    s_cbranch_scc1 L_d67
    s_waitcnt vmcnt(6)
    s_cmp_lt_i32 s95, -2
    s_cbranch_scc0 L_d67
    s_waitcnt vmcnt(4)
L_d67:
    buffer_load_dwordx4 v[236:239], v1, s[36:39], s44 offen offset:3072 nt
    s_add_u32 s44, s44, 16384
    ds_read_b128 v[40:43], v61 offset:15360
    s_waitcnt lgkmcnt(1)
    v_mfma_f32_16x16x32_bf16 v[28:31], v[32:35], v[16:19], v[28:31]
    ds_read_b128 v[32:35], v61 offset:16384
    s_waitcnt lgkmcnt(1)
    v_mfma_f32_16x16x32_bf16 v[28:31], v[40:43], v[20:23], v[28:31]
    ds_read_b128 v[40:43], v61 offset:17408
    s_waitcnt lgkmcnt(1)
    v_mfma_f32_16x16x32_bf16 v[24:27], v[32:35], v[8:11], 0
    ds_read_b128 v[32:35], v61 offset:18432
    s_waitcnt lgkmcnt(1)
    v_mfma_f32_16x16x32_bf16 v[24:27], v[40:43], v[12:15], v[24:27]
    s_nop 1
    v_mov_b32_dpp v44, v28 quad_perm:[0,0,0,0] row_mask:0xf bank_mask:0xf
    v_mov_b32_dpp v45, v30 quad_perm:[2,2,2,2] row_mask:0xf bank_mask:0xf
    s_nop 0
    v_add_f32_dpp v44, v29, v44 quad_perm:[1,1,1,1] row_mask:0xf bank_mask:0xf
    v_add_f32_dpp v45, v31, v45 quad_perm:[3,3,3,3] row_mask:0xf bank_mask:0xf
    v_add_f32 v44, v44, v45
    v_cndmask_b32 v36, v36, v44, s[68:69]
    v_cvt_pk_bf16_f32 v36, v36, v36
    v_and_b32 v36, 0xffff0000, v36
    v_mul_f32 v36, 0x3db504f3, v36
    v_cvt_pk_bf16_f32 v36, v36, v36
    v_and_b32 v36, 0xffff0000, v36
    v_mov_b32 v56, v36
    s_waitcnt vmcnt(7)
    s_cmp_ge_u32 s93, 16
    s_cbranch_scc1 L_d68
    s_waitcnt vmcnt(5)
L_d68:
    buffer_load_dwordx4 v[240:243], v1, s[36:39], s44 offen offset:0 nt
    ds_read_b128 v[40:43], v61 offset:19456
    s_waitcnt lgkmcnt(1)
    v_mfma_f32_16x16x32_bf16 v[24:27], v[32:35], v[16:19], v[24:27]
    ds_read_b128 v[32:35], v61 offset:20480
    s_waitcnt lgkmcnt(1)
    v_mfma_f32_16x16x32_bf16 v[24:27], v[40:43], v[20:23], v[24:27]
    ds_read_b128 v[40:43], v61 offset:21504
    s_waitcnt lgkmcnt(1)
    v_mfma_f32_16x16x32_bf16 v[28:31], v[32:35], v[8:11], 0
    ds_read_b128 v[32:35], v61 offset:22528
    s_waitcnt lgkmcnt(1)
    v_mfma_f32_16x16x32_bf16 v[28:31], v[40:43], v[12:15], v[28:31]
    s_nop 1
    v_mov_b32_dpp v44, v24 quad_perm:[0,0,0,0] row_mask:0xf bank_mask:0xf
    v_mov_b32_dpp v45, v26 quad_perm:[2,2,2,2] row_mask:0xf bank_mask:0xf
    s_nop 0
    v_add_f32_dpp v44, v25, v44 quad_perm:[1,1,1,1] row_mask:0xf bank_mask:0xf
    v_add_f32_dpp v45, v27, v45 quad_perm:[3,3,3,3] row_mask:0xf bank_mask:0xf
    v_add_f32 v37, v44, v45
    s_waitcnt vmcnt(6)
    s_cmp_ge_u32 s93, 16
    s_cbranch_scc1 L_d69
    s_waitcnt vmcnt(5)
L_d69:
    buffer_load_dwordx4 v[244:247], v1, s[36:39], s44 offen offset:1024 nt
    ds_read_b128 v[40:43], v61 offset:23552
    s_waitcnt lgkmcnt(1)
    v_mfma_f32_16x16x32_bf16 v[28:31], v[32:35], v[16:19], v[28:31]
    s_waitcnt lgkmcnt(0)
    v_mfma_f32_16x16x32_bf16 v[28:31], v[40:43], v[20:23], v[28:31]
    v_mfma_f32_16x16x32_bf16 v[24:27], v[64:67], v[8:11], 0
    v_mfma_f32_16x16x32_bf16 v[24:27], v[68:71], v[12:15], v[24:27]
    s_nop 5
    v_mov_b32_dpp v44, v28 quad_perm:[0,0,0,0] row_mask:0xf bank_mask:0xf
    v_mov_b32_dpp v45, v30 quad_perm:[2,2,2,2] row_mask:0xf bank_mask:0xf
    s_nop 0
    v_add_f32_dpp v44, v29, v44 quad_perm:[1,1,1,1] row_mask:0xf bank_mask:0xf
    v_add_f32_dpp v45, v31, v45 quad_perm:[3,3,3,3] row_mask:0xf bank_mask:0xf
    v_add_f32 v44, v44, v45
    v_cndmask_b32 v37, v37, v44, s[64:65]
    s_waitcnt vmcnt(6)
    s_cmp_ge_u32 s93, 16
    s_cbranch_scc1 L_d70
    s_waitcnt vmcnt(4)
L_d70:
    buffer_load_dwordx4 v[248:251], v1, s[36:39], s44 offen offset:2048 nt
    v_mfma_f32_16x16x32_bf16 v[24:27], v[72:75], v[16:19], v[24:27]
    v_mfma_f32_16x16x32_bf16 v[24:27], v[76:79], v[20:23], v[24:27]
    v_mfma_f32_16x16x32_bf16 v[28:31], v[80:83], v[8:11], 0
    v_mfma_f32_16x16x32_bf16 v[28:31], v[84:87], v[12:15], v[28:31]
    s_nop 5
    v_mov_b32_dpp v44, v24 quad_perm:[0,0,0,0] row_mask:0xf bank_mask:0xf
    v_mov_b32_dpp v45, v26 quad_perm:[2,2,2,2] row_mask:0xf bank_mask:0xf
    s_nop 0
    v_add_f32_dpp v44, v25, v44 quad_perm:[1,1,1,1] row_mask:0xf bank_mask:0xf
    v_add_f32_dpp v45, v27, v45 quad_perm:[3,3,3,3] row_mask:0xf bank_mask:0xf
    v_add_f32 v44, v44, v45
    v_cndmask_b32 v37, v37, v44, s[66:67]
    s_waitcnt vmcnt(5)
    s_cmp_ge_u32 s93, 16
    s_cbranch_scc1 L_d71
    s_waitcnt vmcnt(4)
L_d71:
    buffer_load_dwordx4 v[252:255], v1, s[36:39], s44 offen offset:3072 nt
    s_add_u32 s44, s44, 49152
    v_cmp_eq_u32 vcc, v60, v54
    s_nop 0
    s_bcnt1_i32_b64 s93, vcc
    v_mfma_f32_16x16x32_bf16 v[28:31], v[88:91], v[16:19], v[28:31]
    v_mfma_f32_16x16x32_bf16 v[28:31], v[92:95], v[20:23], v[28:31]
    v_mfma_f32_16x16x32_bf16 v[24:27], v[96:99], v[8:11], 0
    v_mfma_f32_16x16x32_bf16 v[24:27], v[100:103], v[12:15], v[24:27]
    s_nop 5
    v_mov_b32_dpp v44, v28 quad_perm:[0,0,0,0] row_mask:0xf bank_mask:0xf
    v_mov_b32_dpp v45, v30 quad_perm:[2,2,2,2] row_mask:0xf bank_mask:0xf
    s_nop 0
    v_add_f32_dpp v44, v29, v44 quad_perm:[1,1,1,1] row_mask:0xf bank_mask:0xf
    v_add_f32_dpp v45, v31, v45 quad_perm:[3,3,3,3] row_mask:0xf bank_mask:0xf
    v_add_f32 v44, v44, v45
    v_cndmask_b32 v37, v37, v44, s[68:69]
    v_cvt_pk_bf16_f32 v37, v37, v37
    v_and_b32 v37, 0xffff0000, v37
    v_mul_f32 v37, 0x3db504f3, v37
    v_cvt_pk_bf16_f32 v37, v37, v37
    v_and_b32 v37, 0xffff0000, v37
    v_max_f32 v56, v56, v37
    s_waitcnt vmcnt(5)
    s_cmp_ge_u32 s93, 16
    s_cbranch_scc1 L_d72
    s_waitcnt vmcnt(4)
L_d72:
    buffer_load_dwordx4 v[64:67], v1, s[36:39], s44 offen offset:0 nt
    v_mfma_f32_16x16x32_bf16 v[24:27], v[104:107], v[16:19], v[24:27]
    v_mfma_f32_16x16x32_bf16 v[24:27], v[108:111], v[20:23], v[24:27]
    v_mfma_f32_16x16x32_bf16 v[28:31], v[112:115], v[8:11], 0
    v_mfma_f32_16x16x32_bf16 v[28:31], v[116:119], v[12:15], v[28:31]
    s_nop 5
    v_mov_b32_dpp v44, v24 quad_perm:[0,0,0,0] row_mask:0xf bank_mask:0xf
    v_mov_b32_dpp v45, v26 quad_perm:[2,2,2,2] row_mask:0xf bank_mask:0xf
    s_nop 0
    v_add_f32_dpp v44, v25, v44 quad_perm:[1,1,1,1] row_mask:0xf bank_mask:0xf
    v_add_f32_dpp v45, v27, v45 quad_perm:[3,3,3,3] row_mask:0xf bank_mask:0xf
    v_add_f32 v38, v44, v45
    s_waitcnt vmcnt(5)
    s_cmp_ge_u32 s93, 16
    s_cbranch_scc1 L_d73
    s_waitcnt vmcnt(4)
L_d73:
    buffer_load_dwordx4 v[68:71], v1, s[36:39], s44 offen offset:1024 nt
    v_mfma_f32_16x16x32_bf16 v[28:31], v[120:123], v[16:19], v[28:31]
    v_mfma_f32_16x16x32_bf16 v[28:31], v[124:127], v[20:23], v[28:31]
    v_mfma_f32_16x16x32_bf16 v[24:27], v[128:131], v[8:11], 0
    v_mfma_f32_16x16x32_bf16 v[24:27], v[132:135], v[12:15], v[24:27]
    s_nop 5
    v_mov_b32_dpp v44, v28 quad_perm:[0,0,0,0] row_mask:0xf bank_mask:0xf
    v_mov_b32_dpp v45, v30 quad_perm:[2,2,2,2] row_mask:0xf bank_mask:0xf
    s_nop 0
    v_add_f32_dpp v44, v29, v44 quad_perm:[1,1,1,1] row_mask:0xf bank_mask:0xf
    v_add_f32_dpp v45, v31, v45 quad_perm:[3,3,3,3] row_mask:0xf bank_mask:0xf
    v_add_f32 v44, v44, v45
    v_cndmask_b32 v38, v38, v44, s[64:65]
    s_waitcnt vmcnt(5)
    s_cmp_ge_u32 s93, 16
    s_cbranch_scc1 L_d74
    s_waitcnt vmcnt(4)
L_d74:
    buffer_load_dwordx4 v[72:75], v1, s[36:39], s44 offen offset:2048 nt
    v_mfma_f32_16x16x32_bf16 v[24:27], v[136:139], v[16:19], v[24:27]
    v_mfma_f32_16x16x32_bf16 v[24:27], v[140:143], v[20:23], v[24:27]
    v_mfma_f32_16x16x32_bf16 v[28:31], v[144:147], v[8:11], 0
    v_mfma_f32_16x16x32_bf16 v[28:31], v[148:151], v[12:15], v[28:31]
    s_nop 5
    v_mov_b32_dpp v44, v24 quad_perm:[0,0,0,0] row_mask:0xf bank_mask:0xf
    v_mov_b32_dpp v45, v26 quad_perm:[2,2,2,2] row_mask:0xf bank_mask:0xf
    s_nop 0
    v_add_f32_dpp v44, v25, v44 quad_perm:[1,1,1,1] row_mask:0xf bank_mask:0xf
    v_add_f32_dpp v45, v27, v45 quad_perm:[3,3,3,3] row_mask:0xf bank_mask:0xf
    v_add_f32 v44, v44, v45
    v_cndmask_b32 v38, v38, v44, s[66:67]
    s_waitcnt vmcnt(5)
    s_cmp_ge_u32 s93, 16
    s_cbranch_scc1 L_d75
    s_waitcnt vmcnt(4)
L_d75:
    buffer_load_dwordx4 v[76:79], v1, s[36:39], s44 offen offset:3072 nt
    s_add_u32 s44, s44, 16384
    v_mfma_f32_16x16x32_bf16 v[28:31], v[152:155], v[16:19], v[28:31]
    v_mfma_f32_16x16x32_bf16 v[28:31], v[156:159], v[20:23], v[28:31]
    v_mfma_f32_16x16x32_bf16 v[24:27], v[160:163], v[8:11], 0
    v_mfma_f32_16x16x32_bf16 v[24:27], v[164:167], v[12:15], v[24:27]
    s_nop 5
    v_mov_b32_dpp v44, v28 quad_perm:[0,0,0,0] row_mask:0xf bank_mask:0xf
    v_mov_b32_dpp v45, v30 quad_perm:[2,2,2,2] row_mask:0xf bank_mask:0xf
    s_nop 0
    v_add_f32_dpp v44, v29, v44 quad_perm:[1,1,1,1] row_mask:0xf bank_mask:0xf
    v_add_f32_dpp v45, v31, v45 quad_perm:[3,3,3,3] row_mask:0xf bank_mask:0xf
    v_add_f32 v44, v44, v45
    v_cndmask_b32 v38, v38, v44, s[68:69]
    v_cvt_pk_bf16_f32 v38, v38, v38
    v_and_b32 v38, 0xffff0000, v38
    v_mul_f32 v38, 0x3db504f3, v38
    v_cvt_pk_bf16_f32 v38, v38, v38
    v_and_b32 v38, 0xffff0000, v38
    v_max_f32 v56, v56, v38
    s_waitcnt vmcnt(5)
    s_cmp_ge_u32 s93, 16
    s_cbranch_scc1 L_d76
    s_waitcnt vmcnt(4)
L_d76:
    buffer_load_dwordx4 v[80:83], v1, s[36:39], s44 offen offset:0 nt
    v_mfma_f32_16x16x32_bf16 v[24:27], v[168:171], v[16:19], v[24:27]
    v_mfma_f32_16x16x32_bf16 v[24:27], v[172:175], v[20:23], v[24:27]
    v_mfma_f32_16x16x32_bf16 v[28:31], v[176:179], v[8:11], 0
    v_mfma_f32_16x16x32_bf16 v[28:31], v[180:183], v[12:15], v[28:31]
    s_nop 5
    v_mov_b32_dpp v44, v24 quad_perm:[0,0,0,0] row_mask:0xf bank_mask:0xf
    v_mov_b32_dpp v45, v26 quad_perm:[2,2,2,2] row_mask:0xf bank_mask:0xf
    s_nop 0
    v_add_f32_dpp v44, v25, v44 quad_perm:[1,1,1,1] row_mask:0xf bank_mask:0xf
    v_add_f32_dpp v45, v27, v45 quad_perm:[3,3,3,3] row_mask:0xf bank_mask:0xf
    v_add_f32 v39, v44, v45
    s_waitcnt vmcnt(5)
    s_cmp_ge_u32 s93, 16
    s_cbranch_scc1 L_d77
    s_waitcnt vmcnt(4)
L_d77:
    buffer_load_dwordx4 v[84:87], v1, s[36:39], s44 offen offset:1024 nt
    v_mfma_f32_16x16x32_bf16 v[28:31], v[184:187], v[16:19], v[28:31]
    v_mfma_f32_16x16x32_bf16 v[28:31], v[188:191], v[20:23], v[28:31]
    v_mfma_f32_16x16x32_bf16 v[24:27], v[192:195], v[8:11], 0
    v_mfma_f32_16x16x32_bf16 v[24:27], v[196:199], v[12:15], v[24:27]
    s_nop 5
    v_mov_b32_dpp v44, v28 quad_perm:[0,0,0,0] row_mask:0xf bank_mask:0xf
    v_mov_b32_dpp v45, v30 quad_perm:[2,2,2,2] row_mask:0xf bank_mask:0xf
    s_nop 0
    v_add_f32_dpp v44, v29, v44 quad_perm:[1,1,1,1] row_mask:0xf bank_mask:0xf
    v_add_f32_dpp v45, v31, v45 quad_perm:[3,3,3,3] row_mask:0xf bank_mask:0xf
    v_add_f32 v44, v44, v45
    v_cndmask_b32 v39, v39, v44, s[64:65]
    s_waitcnt vmcnt(5)
    s_cmp_ge_u32 s93, 16
    s_cbranch_scc1 L_d78
    s_waitcnt vmcnt(4)
L_d78:
    buffer_load_dwordx4 v[88:91], v1, s[36:39], s44 offen offset:2048 nt
    s_mov_b32 s32, 855040
    buffer_load_dword v47, v48, s[48:51], s32 offen nt
    v_mfma_f32_16x16x32_bf16 v[24:27], v[200:203], v[16:19], v[24:27]
    v_mfma_f32_16x16x32_bf16 v[24:27], v[204:207], v[20:23], v[24:27]
    v_mfma_f32_16x16x32_bf16 v[28:31], v[208:211], v[8:11], 0
    v_mfma_f32_16x16x32_bf16 v[28:31], v[212:215], v[12:15], v[28:31]
    s_nop 5
    v_mov_b32_dpp v44, v24 quad_perm:[0,0,0,0] row_mask:0xf bank_mask:0xf
    v_mov_b32_dpp v45, v26 quad_perm:[2,2,2,2] row_mask:0xf bank_mask:0xf
    s_nop 0
    v_add_f32_dpp v44, v25, v44 quad_perm:[1,1,1,1] row_mask:0xf bank_mask:0xf
    v_add_f32_dpp v45, v27, v45 quad_perm:[3,3,3,3] row_mask:0xf bank_mask:0xf
    v_add_f32 v44, v44, v45
    v_cndmask_b32 v39, v39, v44, s[66:67]
    s_waitcnt vmcnt(6)
    s_cmp_ge_u32 s93, 16
    s_cbranch_scc1 L_d79
    s_waitcnt vmcnt(5)
L_d79:
    buffer_load_dwordx4 v[92:95], v1, s[36:39], s44 offen offset:3072 nt
    s_add_u32 s44, s44, 49152
    v_mfma_f32_16x16x32_bf16 v[28:31], v[216:219], v[16:19], v[28:31]
    v_mfma_f32_16x16x32_bf16 v[28:31], v[220:223], v[20:23], v[28:31]
    v_mfma_f32_16x16x32_bf16 v[24:27], v[224:227], v[8:11], 0
    v_mfma_f32_16x16x32_bf16 v[24:27], v[228:231], v[12:15], v[24:27]
    s_nop 5
    v_mov_b32_dpp v44, v28 quad_perm:[0,0,0,0] row_mask:0xf bank_mask:0xf
    v_mov_b32_dpp v45, v30 quad_perm:[2,2,2,2] row_mask:0xf bank_mask:0xf
    s_nop 0
    v_add_f32_dpp v44, v29, v44 quad_perm:[1,1,1,1] row_mask:0xf bank_mask:0xf
    v_add_f32_dpp v45, v31, v45 quad_perm:[3,3,3,3] row_mask:0xf bank_mask:0xf
    v_add_f32 v44, v44, v45
    v_cndmask_b32 v39, v39, v44, s[68:69]
    v_cvt_pk_bf16_f32 v39, v39, v39
    v_and_b32 v39, 0xffff0000, v39
    v_mul_f32 v39, 0x3db504f3, v39
    v_cvt_pk_bf16_f32 v39, v39, v39
    v_and_b32 v39, 0xffff0000, v39
    v_max_f32 v56, v56, v39
    s_waitcnt vmcnt(6)
    s_cmp_ge_u32 s93, 16
    s_cbranch_scc1 L_d80
    s_waitcnt vmcnt(5)
L_d80:
    buffer_load_dwordx4 v[96:99], v1, s[36:39], s44 offen offset:0 nt
    s_mov_b32 s32, 855040
    buffer_store_dword v60, v49, s[48:51], s32 offen
    v_mfma_f32_16x16x32_bf16 v[24:27], v[232:235], v[16:19], v[24:27]
    v_mfma_f32_16x16x32_bf16 v[24:27], v[236:239], v[20:23], v[24:27]
    v_mfma_f32_16x16x32_bf16 v[28:31], v[240:243], v[8:11], 0
    v_mfma_f32_16x16x32_bf16 v[28:31], v[244:247], v[12:15], v[28:31]
    s_nop 5
    v_mov_b32_dpp v44, v24 quad_perm:[0,0,0,0] row_mask:0xf bank_mask:0xf
    v_mov_b32_dpp v45, v26 quad_perm:[2,2,2,2] row_mask:0xf bank_mask:0xf
    s_nop 0
    v_add_f32_dpp v44, v25, v44 quad_perm:[1,1,1,1] row_mask:0xf bank_mask:0xf
    v_add_f32_dpp v45, v27, v45 quad_perm:[3,3,3,3] row_mask:0xf bank_mask:0xf
    v_add_f32 v40, v44, v45
    s_waitcnt vmcnt(7)
    s_cmp_ge_u32 s93, 16
    s_cbranch_scc1 L_d81
    s_waitcnt vmcnt(6)
L_d81:
    buffer_load_dwordx4 v[100:103], v1, s[36:39], s44 offen offset:1024 nt
    v_mfma_f32_16x16x32_bf16 v[28:31], v[248:251], v[16:19], v[28:31]
    v_mfma_f32_16x16x32_bf16 v[28:31], v[252:255], v[20:23], v[28:31]
    v_mfma_f32_16x16x32_bf16 v[24:27], v[64:67], v[8:11], 0
    v_mfma_f32_16x16x32_bf16 v[24:27], v[68:71], v[12:15], v[24:27]
    s_nop 5
    v_mov_b32_dpp v44, v28 quad_perm:[0,0,0,0] row_mask:0xf bank_mask:0xf
    v_mov_b32_dpp v45, v30 quad_perm:[2,2,2,2] row_mask:0xf bank_mask:0xf
    s_nop 0
    v_add_f32_dpp v44, v29, v44 quad_perm:[1,1,1,1] row_mask:0xf bank_mask:0xf
    v_add_f32_dpp v45, v31, v45 quad_perm:[3,3,3,3] row_mask:0xf bank_mask:0xf
    v_add_f32 v44, v44, v45
    v_cndmask_b32 v40, v40, v44, s[64:65]
    s_waitcnt vmcnt(7)
    s_cmp_ge_u32 s93, 16
    s_cbranch_scc1 L_d82
    s_waitcnt vmcnt(6)
L_d82:
    buffer_load_dwordx4 v[104:107], v1, s[36:39], s44 offen offset:2048 nt
    v_mfma_f32_16x16x32_bf16 v[24:27], v[72:75], v[16:19], v[24:27]
    s_waitcnt vmcnt(7)
    s_cmp_ge_u32 s93, 16
    s_cbranch_scc1 L_d83
    s_waitcnt vmcnt(6)
    s_cmp_lt_i32 s95, -10
    s_cbranch_scc0 L_d83
    s_waitcnt vmcnt(4)
L_d83:
    buffer_load_dwordx4 v[108:111], v1, s[36:39], s44 offen offset:3072 nt
    s_add_u32 s44, s44, 16384
    v_mfma_f32_16x16x32_bf16 v[24:27], v[76:79], v[20:23], v[24:27]
    s_waitcnt vmcnt(7)
    s_cmp_ge_u32 s93, 16
    s_cbranch_scc1 L_d84
    s_waitcnt vmcnt(5)
L_d84:
    buffer_load_dwordx4 v[112:115], v1, s[36:39], s44 offen offset:0 nt
    v_mfma_f32_16x16x32_bf16 v[28:31], v[80:83], v[8:11], 0
    s_waitcnt vmcnt(6)
    s_cmp_ge_u32 s93, 16
    s_cbranch_scc1 L_d85
    s_waitcnt vmcnt(5)
L_d85:
    buffer_load_dwordx4 v[116:119], v1, s[36:39], s44 offen offset:1024 nt
    v_mfma_f32_16x16x32_bf16 v[28:31], v[84:87], v[12:15], v[28:31]
    v_mov_b32_dpp v44, v24 quad_perm:[0,0,0,0] row_mask:0xf bank_mask:0xf
    v_mov_b32_dpp v45, v26 quad_perm:[2,2,2,2] row_mask:0xf bank_mask:0xf
    s_nop 0
    v_add_f32_dpp v44, v25, v44 quad_perm:[1,1,1,1] row_mask:0xf bank_mask:0xf
    v_add_f32_dpp v45, v27, v45 quad_perm:[3,3,3,3] row_mask:0xf bank_mask:0xf
    v_add_f32 v44, v44, v45
    v_cndmask_b32 v40, v40, v44, s[66:67]
    v_mfma_f32_16x16x32_bf16 v[28:31], v[88:91], v[16:19], v[28:31]
    s_waitcnt vmcnt(6)
    s_cmp_ge_u32 s93, 16
    s_cbranch_scc1 L_d86
    s_waitcnt vmcnt(4)
L_d86:
    buffer_load_dwordx4 v[120:123], v1, s[36:39], s44 offen offset:2048 nt
    v_mfma_f32_16x16x32_bf16 v[28:31], v[92:95], v[20:23], v[28:31]
    s_waitcnt vmcnt(5)
    s_cmp_ge_u32 s93, 16
    s_cbranch_scc1 L_d87
    s_waitcnt vmcnt(4)
L_d87:
    buffer_load_dwordx4 v[124:127], v1, s[36:39], s44 offen offset:3072 nt
    s_add_u32 s44, s44, 49152
    v_cmp_eq_u32 vcc, v60, v47
    s_nop 0
    s_bcnt1_i32_b64 s93, vcc
    v_mfma_f32_16x16x32_bf16 v[24:27], v[96:99], v[8:11], 0
    v_mfma_f32_16x16x32_bf16 v[24:27], v[100:103], v[12:15], v[24:27]
    v_mov_b32_dpp v44, v28 quad_perm:[0,0,0,0] row_mask:0xf bank_mask:0xf
    v_mov_b32_dpp v45, v30 quad_perm:[2,2,2,2] row_mask:0xf bank_mask:0xf
    s_nop 0
    v_add_f32_dpp v44, v29, v44 quad_perm:[1,1,1,1] row_mask:0xf bank_mask:0xf
    v_add_f32_dpp v45, v31, v45 quad_perm:[3,3,3,3] row_mask:0xf bank_mask:0xf
    v_add_f32 v44, v44, v45
    v_cndmask_b32 v40, v40, v44, s[68:69]
    v_cvt_pk_bf16_f32 v40, v40, v40
    v_and_b32 v40, 0xffff0000, v40
    v_mul_f32 v40, 0x3db504f3, v40
    v_cvt_pk_bf16_f32 v40, v40, v40
    v_and_b32 v40, 0xffff0000, v40
    v_max_f32 v56, v56, v40
    s_waitcnt vmcnt(5)
    s_cmp_ge_u32 s93, 16
    s_cbranch_scc1 L_d88
    s_waitcnt vmcnt(4)
L_d88:
    buffer_load_dwordx4 v[128:131], v1, s[36:39], s44 offen offset:0 nt
    v_mfma_f32_16x16x32_bf16 v[24:27], v[104:107], v[16:19], v[24:27]
    s_waitcnt vmcnt(5)
    s_cmp_ge_u32 s93, 16
    s_cbranch_scc1 L_d89
    s_waitcnt vmcnt(4)
L_d89:
    buffer_load_dwordx4 v[132:135], v1, s[36:39], s44 offen offset:1024 nt
    v_mfma_f32_16x16x32_bf16 v[24:27], v[108:111], v[20:23], v[24:27]
    s_waitcnt vmcnt(5)
    s_cmp_ge_u32 s93, 16
    s_cbranch_scc1 L_d90
    s_waitcnt vmcnt(4)
L_d90:
    buffer_load_dwordx4 v[136:139], v1, s[36:39], s44 offen offset:2048 nt
    v_mfma_f32_16x16x32_bf16 v[28:31], v[112:115], v[8:11], 0
    s_waitcnt vmcnt(5)
    s_cmp_ge_u32 s93, 16
    s_cbranch_scc1 L_d91
    s_waitcnt vmcnt(4)
L_d91:
    buffer_load_dwordx4 v[140:143], v1, s[36:39], s44 offen offset:3072 nt
    s_add_u32 s44, s44, 16384
    v_mfma_f32_16x16x32_bf16 v[28:31], v[116:119], v[12:15], v[28:31]
    v_mov_b32_dpp v44, v24 quad_perm:[0,0,0,0] row_mask:0xf bank_mask:0xf
    v_mov_b32_dpp v45, v26 quad_perm:[2,2,2,2] row_mask:0xf bank_mask:0xf
    s_nop 0
    v_add_f32_dpp v44, v25, v44 quad_perm:[1,1,1,1] row_mask:0xf bank_mask:0xf
    v_add_f32_dpp v45, v27, v45 quad_perm:[3,3,3,3] row_mask:0xf bank_mask:0xf
    v_add_f32 v41, v44, v45
    s_waitcnt vmcnt(5)
    s_cmp_ge_u32 s93, 16
    s_cbranch_scc1 L_d92
    s_waitcnt vmcnt(4)
L_d92:
    buffer_load_dwordx4 v[144:147], v1, s[36:39], s44 offen offset:0 nt
    v_mfma_f32_16x16x32_bf16 v[28:31], v[120:123], v[16:19], v[28:31]
    s_waitcnt vmcnt(5)
    s_cmp_ge_u32 s93, 16
    s_cbranch_scc1 L_d93
    s_waitcnt vmcnt(4)
L_d93:
    buffer_load_dwordx4 v[148:151], v1, s[36:39], s44 offen offset:1024 nt
    v_mfma_f32_16x16x32_bf16 v[28:31], v[124:127], v[20:23], v[28:31]
    s_waitcnt vmcnt(5)
    s_cmp_ge_u32 s93, 16
    s_cbranch_scc1 L_d94
    s_waitcnt vmcnt(4)
L_d94:
    buffer_load_dwordx4 v[152:155], v1, s[36:39], s44 offen offset:2048 nt
    s_mov_b32 s32, 856064
    buffer_load_dword v54, v48, s[48:51], s32 offen nt
    v_mfma_f32_16x16x32_bf16 v[24:27], v[128:131], v[8:11], 0
    s_waitcnt vmcnt(6)
    s_cmp_ge_u32 s93, 16
    s_cbranch_scc1 L_d95
    s_waitcnt vmcnt(5)
L_d95:
    buffer_load_dwordx4 v[156:159], v1, s[36:39], s44 offen offset:3072 nt
    s_add_u32 s44, s44, 49152
    s_waitcnt vmcnt(6)
    s_cmp_ge_u32 s93, 16
    s_cbranch_scc1 L_d96
    s_waitcnt vmcnt(5)
L_d96:
    buffer_load_dwordx4 v[160:163], v1, s[36:39], s44 offen offset:0 nt
    s_mov_b32 s32, 856064
    buffer_store_dword v60, v49, s[48:51], s32 offen
    v_mfma_f32_16x16x32_bf16 v[24:27], v[132:135], v[12:15], v[24:27]
    v_mov_b32_dpp v44, v28 quad_perm:[0,0,0,0] row_mask:0xf bank_mask:0xf
    v_mov_b32_dpp v45, v30 quad_perm:[2,2,2,2] row_mask:0xf bank_mask:0xf
    s_nop 0
    v_add_f32_dpp v44, v29, v44 quad_perm:[1,1,1,1] row_mask:0xf bank_mask:0xf
    v_add_f32_dpp v45, v31, v45 quad_perm:[3,3,3,3] row_mask:0xf bank_mask:0xf
    v_add_f32 v44, v44, v45
    v_cndmask_b32 v41, v41, v44, s[64:65]
    s_waitcnt vmcnt(7)
    s_cmp_ge_u32 s93, 16
    s_cbranch_scc1 L_d97
    s_waitcnt vmcnt(6)
L_d97:
    buffer_load_dwordx4 v[164:167], v1, s[36:39], s44 offen offset:1024 nt
    s_waitcnt vmcnt(7)
    s_cmp_ge_u32 s93, 16
    s_cbranch_scc1 L_d98
    s_waitcnt vmcnt(6)
L_d98:
    buffer_load_dwordx4 v[168:171], v1, s[36:39], s44 offen offset:2048 nt
    v_mfma_f32_16x16x32_bf16 v[24:27], v[136:139], v[16:19], v[24:27]
    s_waitcnt vmcnt(7)
    s_cmp_ge_u32 s93, 16
    s_cbranch_scc1 L_d99
    s_waitcnt vmcnt(6)
    s_cmp_lt_i32 s95, -6
    s_cbranch_scc0 L_d99
    s_waitcnt vmcnt(4)
L_d99:
    buffer_load_dwordx4 v[172:175], v1, s[36:39], s44 offen offset:3072 nt
    s_add_u32 s44, s44, 16384
    v_mfma_f32_16x16x32_bf16 v[24:27], v[140:143], v[20:23], v[24:27]
    s_waitcnt vmcnt(7)
    s_cmp_ge_u32 s93, 16
    s_cbranch_scc1 L_d100
    s_waitcnt vmcnt(5)
L_d100:
    buffer_load_dwordx4 v[176:179], v1, s[36:39], s44 offen offset:0 nt
    v_mfma_f32_16x16x32_bf16 v[28:31], v[144:147], v[8:11], 0
    s_waitcnt vmcnt(6)
    s_cmp_ge_u32 s93, 16
    s_cbranch_scc1 L_d101
    s_waitcnt vmcnt(5)
L_d101:
    buffer_load_dwordx4 v[180:183], v1, s[36:39], s44 offen offset:1024 nt
    v_mfma_f32_16x16x32_bf16 v[28:31], v[148:151], v[12:15], v[28:31]
    v_mov_b32_dpp v44, v24 quad_perm:[0,0,0,0] row_mask:0xf bank_mask:0xf
    v_mov_b32_dpp v45, v26 quad_perm:[2,2,2,2] row_mask:0xf bank_mask:0xf
    s_nop 0
    v_add_f32_dpp v44, v25, v44 quad_perm:[1,1,1,1] row_mask:0xf bank_mask:0xf
    v_add_f32_dpp v45, v27, v45 quad_perm:[3,3,3,3] row_mask:0xf bank_mask:0xf
    v_add_f32 v44, v44, v45
    v_cndmask_b32 v41, v41, v44, s[66:67]
    v_mfma_f32_16x16x32_bf16 v[28:31], v[152:155], v[16:19], v[28:31]
    s_waitcnt vmcnt(6)
    s_cmp_ge_u32 s93, 16
    s_cbranch_scc1 L_d102
    s_waitcnt vmcnt(4)
L_d102:
    buffer_load_dwordx4 v[184:187], v1, s[36:39], s44 offen offset:2048 nt
    v_mfma_f32_16x16x32_bf16 v[28:31], v[156:159], v[20:23], v[28:31]
    s_waitcnt vmcnt(5)
    s_cmp_ge_u32 s93, 16
    s_cbranch_scc1 L_d103
    s_waitcnt vmcnt(4)
L_d103:
    buffer_load_dwordx4 v[188:191], v1, s[36:39], s44 offen offset:3072 nt
    s_add_u32 s44, s44, 49152
    v_cmp_eq_u32 vcc, v60, v54
    s_nop 0
    s_bcnt1_i32_b64 s93, vcc
    v_mfma_f32_16x16x32_bf16 v[24:27], v[160:163], v[8:11], 0
    v_mfma_f32_16x16x32_bf16 v[24:27], v[164:167], v[12:15], v[24:27]
    v_mov_b32_dpp v44, v28 quad_perm:[0,0,0,0] row_mask:0xf bank_mask:0xf
    v_mov_b32_dpp v45, v30 quad_perm:[2,2,2,2] row_mask:0xf bank_mask:0xf
    s_nop 0
    v_add_f32_dpp v44, v29, v44 quad_perm:[1,1,1,1] row_mask:0xf bank_mask:0xf
    v_add_f32_dpp v45, v31, v45 quad_perm:[3,3,3,3] row_mask:0xf bank_mask:0xf
    v_add_f32 v44, v44, v45
    v_cndmask_b32 v41, v41, v44, s[68:69]
    v_cvt_pk_bf16_f32 v41, v41, v41
    v_and_b32 v41, 0xffff0000, v41
    v_mul_f32 v41, 0x3db504f3, v41
    v_cvt_pk_bf16_f32 v41, v41, v41
    v_and_b32 v41, 0xffff0000, v41
    v_max_f32 v56, v56, v41
    s_waitcnt vmcnt(5)
    s_cmp_ge_u32 s93, 16
    s_cbranch_scc1 L_d104
    s_waitcnt vmcnt(4)
L_d104:
    buffer_load_dwordx4 v[192:195], v1, s[36:39], s44 offen offset:0 nt
    v_mfma_f32_16x16x32_bf16 v[24:27], v[168:171], v[16:19], v[24:27]
    s_waitcnt vmcnt(5)
    s_cmp_ge_u32 s93, 16
    s_cbranch_scc1 L_d105
    s_waitcnt vmcnt(4)
L_d105:
    buffer_load_dwordx4 v[196:199], v1, s[36:39], s44 offen offset:1024 nt
    v_mfma_f32_16x16x32_bf16 v[24:27], v[172:175], v[20:23], v[24:27]
    s_waitcnt vmcnt(5)
    s_cmp_ge_u32 s93, 16
    s_cbranch_scc1 L_d106
    s_waitcnt vmcnt(4)
L_d106:
    buffer_load_dwordx4 v[200:203], v1, s[36:39], s44 offen offset:2048 nt
    v_mfma_f32_16x16x32_bf16 v[28:31], v[176:179], v[8:11], 0
    s_waitcnt vmcnt(5)
    s_cmp_ge_u32 s93, 16
    s_cbranch_scc1 L_d107
    s_waitcnt vmcnt(4)
L_d107:
    buffer_load_dwordx4 v[204:207], v1, s[36:39], s44 offen offset:3072 nt
    s_add_u32 s44, s44, 16384
    v_mfma_f32_16x16x32_bf16 v[28:31], v[180:183], v[12:15], v[28:31]
    v_mov_b32_dpp v44, v24 quad_perm:[0,0,0,0] row_mask:0xf bank_mask:0xf
    v_mov_b32_dpp v45, v26 quad_perm:[2,2,2,2] row_mask:0xf bank_mask:0xf
    s_nop 0
    v_add_f32_dpp v44, v25, v44 quad_perm:[1,1,1,1] row_mask:0xf bank_mask:0xf
    v_add_f32_dpp v45, v27, v45 quad_perm:[3,3,3,3] row_mask:0xf bank_mask:0xf
    v_add_f32 v42, v44, v45
    s_waitcnt vmcnt(5)
    s_cmp_ge_u32 s93, 16
    s_cbranch_scc1 L_d108
    s_waitcnt vmcnt(4)
L_d108:
    buffer_load_dwordx4 v[208:211], v1, s[36:39], s44 offen offset:0 nt
    v_mfma_f32_16x16x32_bf16 v[28:31], v[184:187], v[16:19], v[28:31]
    s_waitcnt vmcnt(5)
    s_cmp_ge_u32 s93, 16
    s_cbranch_scc1 L_d109
    s_waitcnt vmcnt(4)
L_d109:
    buffer_load_dwordx4 v[212:215], v1, s[36:39], s44 offen offset:1024 nt
    v_mfma_f32_16x16x32_bf16 v[28:31], v[188:191], v[20:23], v[28:31]
    s_waitcnt vmcnt(5)
    s_cmp_ge_u32 s93, 16
    s_cbranch_scc1 L_d110
    s_waitcnt vmcnt(4)
L_d110:
    buffer_load_dwordx4 v[216:219], v1, s[36:39], s44 offen offset:2048 nt
    s_mov_b32 s32, 857088
    buffer_load_dword v47, v48, s[48:51], s32 offen nt
    v_mfma_f32_16x16x32_bf16 v[24:27], v[192:195], v[8:11], 0
    s_waitcnt vmcnt(6)
    s_cmp_ge_u32 s93, 16
    s_cbranch_scc1 L_d111
    s_waitcnt vmcnt(5)
L_d111:
    buffer_load_dwordx4 v[220:223], v1, s[36:39], s44 offen offset:3072 nt
    s_add_u32 s44, s44, 49152
    s_waitcnt vmcnt(6)
    s_cmp_ge_u32 s93, 16
    s_cbranch_scc1 L_d112
    s_waitcnt vmcnt(5)
L_d112:
    buffer_load_dwordx4 v[224:227], v1, s[36:39], s44 offen offset:0 nt
    s_mov_b32 s32, 857088
    buffer_store_dword v60, v49, s[48:51], s32 offen
    v_mfma_f32_16x16x32_bf16 v[24:27], v[196:199], v[12:15], v[24:27]
    v_mov_b32_dpp v44, v28 quad_perm:[0,0,0,0] row_mask:0xf bank_mask:0xf
    v_mov_b32_dpp v45, v30 quad_perm:[2,2,2,2] row_mask:0xf bank_mask:0xf
    s_nop 0
    v_add_f32_dpp v44, v29, v44 quad_perm:[1,1,1,1] row_mask:0xf bank_mask:0xf
    v_add_f32_dpp v45, v31, v45 quad_perm:[3,3,3,3] row_mask:0xf bank_mask:0xf
    v_add_f32 v44, v44, v45
    v_cndmask_b32 v42, v42, v44, s[64:65]
    s_waitcnt vmcnt(7)
    s_cmp_ge_u32 s93, 16
    s_cbranch_scc1 L_d113
    s_waitcnt vmcnt(6)
L_d113:
    buffer_load_dwordx4 v[228:231], v1, s[36:39], s44 offen offset:1024 nt
    s_waitcnt vmcnt(7)
    s_cmp_ge_u32 s93, 16
    s_cbranch_scc1 L_d114
    s_waitcnt vmcnt(6)
L_d114:
    buffer_load_dwordx4 v[232:235], v1, s[36:39], s44 offen offset:2048 nt
    v_mfma_f32_16x16x32_bf16 v[24:27], v[200:203], v[16:19], v[24:27]
    s_waitcnt vmcnt(7)
    s_cmp_ge_u32 s93, 16
    s_cbranch_scc1 L_d115
    s_waitcnt vmcnt(6)
    s_cmp_lt_i32 s95, -14
    s_cbranch_scc0 L_d115
    s_waitcnt vmcnt(4)
L_d115:
    buffer_load_dwordx4 v[236:239], v1, s[36:39], s44 offen offset:3072 nt
    s_add_u32 s44, s44, 16384
    v_mfma_f32_16x16x32_bf16 v[24:27], v[204:207], v[20:23], v[24:27]
    s_waitcnt vmcnt(7)
    s_cmp_ge_u32 s93, 16
    s_cbranch_scc1 L_d116
    s_waitcnt vmcnt(5)
L_d116:
    buffer_load_dwordx4 v[240:243], v1, s[36:39], s44 offen offset:0 nt
    v_mfma_f32_16x16x32_bf16 v[28:31], v[208:211], v[8:11], 0
    s_waitcnt vmcnt(6)
    s_cmp_ge_u32 s93, 16
    s_cbranch_scc1 L_d117
    s_waitcnt vmcnt(5)
L_d117:
    buffer_load_dwordx4 v[244:247], v1, s[36:39], s44 offen offset:1024 nt
    v_mfma_f32_16x16x32_bf16 v[28:31], v[212:215], v[12:15], v[28:31]
    v_mov_b32_dpp v44, v24 quad_perm:[0,0,0,0] row_mask:0xf bank_mask:0xf
    v_mov_b32_dpp v45, v26 quad_perm:[2,2,2,2] row_mask:0xf bank_mask:0xf
    s_nop 0
    v_add_f32_dpp v44, v25, v44 quad_perm:[1,1,1,1] row_mask:0xf bank_mask:0xf
    v_add_f32_dpp v45, v27, v45 quad_perm:[3,3,3,3] row_mask:0xf bank_mask:0xf
    v_add_f32 v44, v44, v45
    v_cndmask_b32 v42, v42, v44, s[66:67]
    v_mfma_f32_16x16x32_bf16 v[28:31], v[216:219], v[16:19], v[28:31]
    s_waitcnt vmcnt(6)
    s_cmp_ge_u32 s93, 16
    s_cbranch_scc1 L_d118
    s_waitcnt vmcnt(4)
L_d118:
    buffer_load_dwordx4 v[248:251], v1, s[36:39], s44 offen offset:2048 nt
    v_mfma_f32_16x16x32_bf16 v[28:31], v[220:223], v[20:23], v[28:31]
    s_waitcnt vmcnt(5)
    s_cmp_ge_u32 s93, 16
    s_cbranch_scc1 L_d119
    s_waitcnt vmcnt(4)
L_d119:
    buffer_load_dwordx4 v[252:255], v1, s[36:39], s44 offen offset:3072 nt
    s_add_u32 s44, s44, 49152
    v_cmp_eq_u32 vcc, v60, v47
    s_nop 0
    s_bcnt1_i32_b64 s93, vcc
    v_mfma_f32_16x16x32_bf16 v[24:27], v[224:227], v[8:11], 0
    v_mfma_f32_16x16x32_bf16 v[24:27], v[228:231], v[12:15], v[24:27]
    v_mov_b32_dpp v44, v28 quad_perm:[0,0,0,0] row_mask:0xf bank_mask:0xf
    v_mov_b32_dpp v45, v30 quad_perm:[2,2,2,2] row_mask:0xf bank_mask:0xf
    s_nop 0
    v_add_f32_dpp v44, v29, v44 quad_perm:[1,1,1,1] row_mask:0xf bank_mask:0xf
    v_add_f32_dpp v45, v31, v45 quad_perm:[3,3,3,3] row_mask:0xf bank_mask:0xf
    v_add_f32 v44, v44, v45
    v_cndmask_b32 v42, v42, v44, s[68:69]
    v_cvt_pk_bf16_f32 v42, v42, v42
    v_and_b32 v42, 0xffff0000, v42
    v_mul_f32 v42, 0x3db504f3, v42
    v_cvt_pk_bf16_f32 v42, v42, v42
    v_and_b32 v42, 0xffff0000, v42
    v_max_f32 v56, v56, v42
    s_waitcnt vmcnt(5)
    s_cmp_ge_u32 s93, 16
    s_cbranch_scc1 L_d120
    s_waitcnt vmcnt(4)
L_d120:
    buffer_load_dwordx4 v[64:67], v1, s[36:39], s44 offen offset:0 nt
    v_mfma_f32_16x16x32_bf16 v[24:27], v[232:235], v[16:19], v[24:27]
    s_waitcnt vmcnt(5)
    s_cmp_ge_u32 s93, 16
    s_cbranch_scc1 L_d121
    s_waitcnt vmcnt(4)
L_d121:
    buffer_load_dwordx4 v[68:71], v1, s[36:39], s44 offen offset:1024 nt
    v_mfma_f32_16x16x32_bf16 v[24:27], v[236:239], v[20:23], v[24:27]
    s_waitcnt vmcnt(5)
    s_cmp_ge_u32 s93, 16
    s_cbranch_scc1 L_d122
    s_waitcnt vmcnt(4)
L_d122:
    buffer_load_dwordx4 v[72:75], v1, s[36:39], s44 offen offset:2048 nt
    v_mfma_f32_16x16x32_bf16 v[28:31], v[240:243], v[8:11], 0
    s_waitcnt vmcnt(5)
    s_cmp_ge_u32 s93, 16
    s_cbranch_scc1 L_d123
    s_waitcnt vmcnt(4)
L_d123:
    buffer_load_dwordx4 v[76:79], v1, s[36:39], s44 offen offset:3072 nt
    s_add_u32 s44, s44, 16384
    v_mfma_f32_16x16x32_bf16 v[28:31], v[244:247], v[12:15], v[28:31]
    v_mov_b32_dpp v44, v24 quad_perm:[0,0,0,0] row_mask:0xf bank_mask:0xf
    v_mov_b32_dpp v45, v26 quad_perm:[2,2,2,2] row_mask:0xf bank_mask:0xf
    s_nop 0
    v_add_f32_dpp v44, v25, v44 quad_perm:[1,1,1,1] row_mask:0xf bank_mask:0xf
    v_add_f32_dpp v45, v27, v45 quad_perm:[3,3,3,3] row_mask:0xf bank_mask:0xf
    v_add_f32 v43, v44, v45
    s_waitcnt vmcnt(5)
    s_cmp_ge_u32 s93, 16
    s_cbranch_scc1 L_d124
    s_waitcnt vmcnt(4)
L_d124:
    buffer_load_dwordx4 v[80:83], v1, s[36:39], s44 offen offset:0 nt
    v_mfma_f32_16x16x32_bf16 v[28:31], v[248:251], v[16:19], v[28:31]
    s_waitcnt vmcnt(5)
    s_cmp_ge_u32 s93, 16
    s_cbranch_scc1 L_d125
    s_waitcnt vmcnt(4)
L_d125:
    buffer_load_dwordx4 v[84:87], v1, s[36:39], s44 offen offset:1024 nt
    v_mfma_f32_16x16x32_bf16 v[28:31], v[252:255], v[20:23], v[28:31]
    s_waitcnt vmcnt(5)
    s_cmp_ge_u32 s93, 16
    s_cbranch_scc1 L_d126
    s_waitcnt vmcnt(4)
L_d126:
    buffer_load_dwordx4 v[88:91], v1, s[36:39], s44 offen offset:2048 nt
    s_mov_b32 s32, 858112
    buffer_load_dword v54, v48, s[48:51], s32 offen nt
    v_mfma_f32_16x16x32_bf16 v[24:27], v[64:67], v[8:11], 0
    s_waitcnt vmcnt(6)
    s_cmp_ge_u32 s93, 16
    s_cbranch_scc1 L_d127
    s_waitcnt vmcnt(5)
L_d127:
    buffer_load_dwordx4 v[92:95], v1, s[36:39], s44 offen offset:3072 nt
    s_waitcnt vmcnt(6)
    s_cmp_ge_u32 s93, 16
    s_cbranch_scc1 L_d128
    s_waitcnt vmcnt(5)
L_d128:
    buffer_load_dwordx4 v[96:99], v2, s[40:43], s45 offen offset:0 nt
    s_mov_b32 s32, 858112
    buffer_store_dword v60, v49, s[48:51], s32 offen
    v_mfma_f32_16x16x32_bf16 v[24:27], v[68:71], v[12:15], v[24:27]
    v_mov_b32_dpp v44, v28 quad_perm:[0,0,0,0] row_mask:0xf bank_mask:0xf
    v_mov_b32_dpp v45, v30 quad_perm:[2,2,2,2] row_mask:0xf bank_mask:0xf
    s_nop 0
    v_add_f32_dpp v44, v29, v44 quad_perm:[1,1,1,1] row_mask:0xf bank_mask:0xf
    v_add_f32_dpp v45, v31, v45 quad_perm:[3,3,3,3] row_mask:0xf bank_mask:0xf
    v_add_f32 v44, v44, v45
    v_cndmask_b32 v43, v43, v44, s[64:65]
    s_waitcnt vmcnt(7)
    s_cmp_ge_u32 s93, 16
    s_cbranch_scc1 L_d129
    s_waitcnt vmcnt(6)
L_d129:
    buffer_load_dwordx4 v[100:103], v2, s[40:43], s45 offen offset:1024 nt
    s_waitcnt vmcnt(7)
    s_cmp_ge_u32 s93, 16
    s_cbranch_scc1 L_d130
    s_waitcnt vmcnt(6)
L_d130:
    buffer_load_dwordx4 v[104:107], v2, s[40:43], s45 offen offset:2048 nt
    v_mfma_f32_16x16x32_bf16 v[24:27], v[72:75], v[16:19], v[24:27]
    s_waitcnt vmcnt(7)
    s_cmp_ge_u32 s93, 16
    s_cbranch_scc1 L_d131
    s_waitcnt vmcnt(6)
    s_cmp_lt_i32 s95, -1
    s_cbranch_scc0 L_d131
    s_waitcnt vmcnt(4)
L_d131:
    buffer_load_dwordx4 v[108:111], v2, s[40:43], s45 offen offset:3072 nt
    s_add_u32 s45, s45, 16384
    v_mfma_f32_16x16x32_bf16 v[24:27], v[76:79], v[20:23], v[24:27]
    s_waitcnt vmcnt(7)
    s_cmp_ge_u32 s93, 16
    s_cbranch_scc1 L_d132
    s_waitcnt vmcnt(5)
L_d132:
    buffer_load_dwordx4 v[112:115], v2, s[40:43], s45 offen offset:0 nt
    v_mfma_f32_16x16x32_bf16 v[28:31], v[80:83], v[8:11], 0
    s_waitcnt vmcnt(6)
    s_cmp_ge_u32 s93, 16
    s_cbranch_scc1 L_d133
    s_waitcnt vmcnt(5)
L_d133:
    buffer_load_dwordx4 v[116:119], v2, s[40:43], s45 offen offset:1024 nt
    v_mfma_f32_16x16x32_bf16 v[28:31], v[84:87], v[12:15], v[28:31]
    v_mov_b32_dpp v44, v24 quad_perm:[0,0,0,0] row_mask:0xf bank_mask:0xf
    v_mov_b32_dpp v45, v26 quad_perm:[2,2,2,2] row_mask:0xf bank_mask:0xf
    s_nop 0
    v_add_f32_dpp v44, v25, v44 quad_perm:[1,1,1,1] row_mask:0xf bank_mask:0xf
    v_add_f32_dpp v45, v27, v45 quad_perm:[3,3,3,3] row_mask:0xf bank_mask:0xf
    v_add_f32 v44, v44, v45
    v_cndmask_b32 v43, v43, v44, s[66:67]
    v_mfma_f32_16x16x32_bf16 v[28:31], v[88:91], v[16:19], v[28:31]
    s_waitcnt vmcnt(6)
    s_cmp_ge_u32 s93, 16
    s_cbranch_scc1 L_d134
    s_waitcnt vmcnt(4)
L_d134:
    buffer_load_dwordx4 v[120:123], v2, s[40:43], s45 offen offset:2048 nt
    v_mfma_f32_16x16x32_bf16 v[28:31], v[92:95], v[20:23], v[28:31]
    s_nop 7
    v_mov_b32_dpp v44, v28 quad_perm:[0,0,0,0] row_mask:0xf bank_mask:0xf
    v_mov_b32_dpp v45, v30 quad_perm:[2,2,2,2] row_mask:0xf bank_mask:0xf
    s_nop 0
    v_add_f32_dpp v44, v29, v44 quad_perm:[1,1,1,1] row_mask:0xf bank_mask:0xf
    v_add_f32_dpp v45, v31, v45 quad_perm:[3,3,3,3] row_mask:0xf bank_mask:0xf
    v_add_f32 v44, v44, v45
    v_cndmask_b32 v43, v43, v44, s[68:69]
    v_cvt_pk_bf16_f32 v43, v43, v43
    v_and_b32 v43, 0xffff0000, v43
    v_mul_f32 v43, 0x3db504f3, v43
    v_cvt_pk_bf16_f32 v43, v43, v43
    v_and_b32 v43, 0xffff0000, v43
    v_max_f32 v56, v56, v43
    s_nop 1
    v_max_f32_dpp v56, v56, v56 quad_perm:[1,0,3,2] row_mask:0xf bank_mask:0xf
    s_nop 1
    v_max_f32_dpp v56, v56, v56 quad_perm:[2,3,0,1] row_mask:0xf bank_mask:0xf
    s_nop 1
    v_max_f32_dpp v56, v56, v56 row_ror:4 row_mask:0xf bank_mask:0xf
    s_nop 1
    v_max_f32_dpp v56, v56, v56 row_ror:8 row_mask:0xf bank_mask:0xf
    v_mov_b32 v44, v56
    s_nop 1
    v_permlane16_swap_b32 v56, v44
    v_max_f32 v56, v56, v44
    v_mov_b32 v44, v56
    s_nop 1
    v_permlane32_swap_b32 v56, v44
    v_max_f32 v56, v56, v44
    s_waitcnt vmcnt(5)
    s_cmp_ge_u32 s93, 16
    s_cbranch_scc1 L_d135
    s_waitcnt vmcnt(4)
L_d135:
    buffer_load_dwordx4 v[124:127], v2, s[40:43], s45 offen offset:3072 nt
    s_add_u32 s45, s45, 49152
    v_cmp_eq_u32 vcc, v60, v54
    s_nop 0
    s_bcnt1_i32_b64 s93, vcc
    v_sub_f32 v36, v36, v56
    v_sub_f32 v37, v37, v56
    v_sub_f32 v38, v38, v56
    v_sub_f32 v39, v39, v56
    v_mul_f32 v36, 0x3fb8aa3b, v36
    v_mul_f32 v37, 0x3fb8aa3b, v37
    v_mul_f32 v38, 0x3fb8aa3b, v38
    v_mul_f32 v39, 0x3fb8aa3b, v39
    v_exp_f32 v36, v36
    v_exp_f32 v37, v37
    v_exp_f32 v38, v38
    v_exp_f32 v39, v39
    v_mov_b32 v57, v36
    v_cvt_pk_bf16_f32 v36, v36, v36
    v_add_f32 v57, v57, v37
    v_cvt_pk_bf16_f32 v37, v37, v37
    v_add_f32 v57, v57, v38
    v_cvt_pk_bf16_f32 v38, v38, v38
    v_add_f32 v57, v57, v39
    v_cvt_pk_bf16_f32 v39, v39, v39
    s_waitcnt vmcnt(5)
    s_cmp_ge_u32 s93, 16
    s_cbranch_scc1 L_d136
    s_waitcnt vmcnt(4)
L_d136:
    buffer_load_dwordx4 v[128:131], v2, s[40:43], s45 offen offset:0 nt
    v_sub_f32 v40, v40, v56
    v_sub_f32 v41, v41, v56
    v_sub_f32 v42, v42, v56
    v_sub_f32 v43, v43, v56
    v_mul_f32 v40, 0x3fb8aa3b, v40
    v_mul_f32 v41, 0x3fb8aa3b, v41
    v_mul_f32 v42, 0x3fb8aa3b, v42
    v_mul_f32 v43, 0x3fb8aa3b, v43
    v_exp_f32 v40, v40
    v_exp_f32 v41, v41
    v_exp_f32 v42, v42
    v_exp_f32 v43, v43
    v_add_f32 v57, v57, v40
    v_cvt_pk_bf16_f32 v40, v40, v40
    v_add_f32 v57, v57, v41
    v_cvt_pk_bf16_f32 v41, v41, v41
    v_add_f32 v57, v57, v42
    v_cvt_pk_bf16_f32 v42, v42, v42
    v_add_f32 v57, v57, v43
    v_cvt_pk_bf16_f32 v43, v43, v43
    s_waitcnt vmcnt(5)
    s_cmp_ge_u32 s93, 16
    s_cbranch_scc1 L_d137
    s_waitcnt vmcnt(4)
L_d137:
    buffer_load_dwordx4 v[132:135], v2, s[40:43], s45 offen offset:1024 nt
    v_add_f32_dpp v57, v57, v57 quad_perm:[1,0,3,2] row_mask:0xf bank_mask:0xf
    s_nop 1
    v_add_f32_dpp v57, v57, v57 quad_perm:[2,3,0,1] row_mask:0xf bank_mask:0xf
    s_nop 1
    v_add_f32_dpp v57, v57, v57 row_ror:4 row_mask:0xf bank_mask:0xf
    s_nop 1
    v_add_f32_dpp v57, v57, v57 row_ror:8 row_mask:0xf bank_mask:0xf
    v_mov_b32 v44, v57
    s_nop 1
    v_permlane16_swap_b32 v57, v44
    v_add_f32 v57, v57, v44
    v_mov_b32 v44, v57
    s_nop 1
    v_permlane32_swap_b32 v57, v44
    v_add_f32 v57, v57, v44
    s_lshl_b32 s32, s3, 3
    v_mov_b32 v44, s32
    s_mov_b64 exec, 1
    ds_write_b64 v44, v[56:57] offset:3328
    s_mov_b64 exec, -1
    s_mul_i32 s32, s3, 320
    s_add_u32 s32, s32, 2048
    v_lshl_add_u32 v50, v50, 3, s32
    v_lshl_add_u32 v50, v51, 2, v50
    v_mov_b32 v24, 0
    v_mov_b32 v25, 0
    v_mov_b32 v26, 0
    v_mov_b32 v27, 0
    s_waitcnt vmcnt(5)
    s_cmp_ge_u32 s93, 16
    s_cbranch_scc1 L_d138
    s_waitcnt vmcnt(4)
L_d138:
    buffer_load_dwordx4 v[136:139], v2, s[40:43], s45 offen offset:2048 nt
    v_and_b32_dpp v8, v36, v4 row_newbcast:0 row_mask:0xf bank_mask:0xf
    v_and_b32_dpp v9, v36, v5 row_newbcast:0 row_mask:0xf bank_mask:0xf
    v_and_b32_dpp v10, v36, v6 row_newbcast:0 row_mask:0xf bank_mask:0xf
    v_and_b32_dpp v11, v36, v7 row_newbcast:0 row_mask:0xf bank_mask:0xf
    v_and_b32_dpp v12, v36, v4 row_newbcast:4 row_mask:0xf bank_mask:0xf
    v_and_b32_dpp v13, v36, v5 row_newbcast:4 row_mask:0xf bank_mask:0xf
    v_and_b32_dpp v14, v36, v6 row_newbcast:4 row_mask:0xf bank_mask:0xf
    v_and_b32_dpp v15, v36, v7 row_newbcast:4 row_mask:0xf bank_mask:0xf
    v_and_b32_dpp v16, v36, v4 row_newbcast:8 row_mask:0xf bank_mask:0xf
    v_and_b32_dpp v17, v36, v5 row_newbcast:8 row_mask:0xf bank_mask:0xf
    v_and_b32_dpp v18, v36, v6 row_newbcast:8 row_mask:0xf bank_mask:0xf
    v_and_b32_dpp v19, v36, v7 row_newbcast:8 row_mask:0xf bank_mask:0xf
    v_mfma_f32_16x16x32_bf16 v[32:35], v[8:11], v[96:99], 0
    s_waitcnt vmcnt(5)
    s_cmp_ge_u32 s93, 16
    s_cbranch_scc1 L_d139
    s_waitcnt vmcnt(4)
L_d139:
    buffer_load_dwordx4 v[140:143], v2, s[40:43], s45 offen offset:3072 nt
    s_add_u32 s45, s45, 16384
    v_and_b32_dpp v20, v36, v4 row_newbcast:12 row_mask:0xf bank_mask:0xf
    v_and_b32_dpp v21, v36, v5 row_newbcast:12 row_mask:0xf bank_mask:0xf
    v_and_b32_dpp v22, v36, v6 row_newbcast:12 row_mask:0xf bank_mask:0xf
    v_and_b32_dpp v23, v36, v7 row_newbcast:12 row_mask:0xf bank_mask:0xf
    v_mfma_f32_16x16x32_bf16 v[32:35], v[12:15], v[100:103], v[32:35]
    v_and_b32_dpp v8, v36, v4 row_newbcast:1 row_mask:0xf bank_mask:0xf
    v_and_b32_dpp v9, v36, v5 row_newbcast:1 row_mask:0xf bank_mask:0xf
    v_and_b32_dpp v10, v36, v6 row_newbcast:1 row_mask:0xf bank_mask:0xf
    v_and_b32_dpp v11, v36, v7 row_newbcast:1 row_mask:0xf bank_mask:0xf
    v_mfma_f32_16x16x32_bf16 v[32:35], v[16:19], v[104:107], v[32:35]
    v_and_b32_dpp v12, v36, v4 row_newbcast:5 row_mask:0xf bank_mask:0xf
    v_and_b32_dpp v13, v36, v5 row_newbcast:5 row_mask:0xf bank_mask:0xf
    v_and_b32_dpp v14, v36, v6 row_newbcast:5 row_mask:0xf bank_mask:0xf
    v_and_b32_dpp v15, v36, v7 row_newbcast:5 row_mask:0xf bank_mask:0xf
    s_waitcnt vmcnt(5)
    s_cmp_ge_u32 s93, 16
    s_cbranch_scc1 L_d140
    s_waitcnt vmcnt(4)
L_d140:
    buffer_load_dwordx4 v[144:147], v2, s[40:43], s45 offen offset:0 nt
    v_mfma_f32_16x16x32_bf16 v[32:35], v[20:23], v[108:111], v[32:35]
    v_and_b32_dpp v16, v36, v4 row_newbcast:9 row_mask:0xf bank_mask:0xf
    v_and_b32_dpp v17, v36, v5 row_newbcast:9 row_mask:0xf bank_mask:0xf
    v_and_b32_dpp v18, v36, v6 row_newbcast:9 row_mask:0xf bank_mask:0xf
    v_and_b32_dpp v19, v36, v7 row_newbcast:9 row_mask:0xf bank_mask:0xf
    v_mfma_f32_16x16x32_bf16 v[32:35], v[8:11], v[112:115], v[32:35]
    v_and_b32_dpp v20, v36, v4 row_newbcast:13 row_mask:0xf bank_mask:0xf
    v_and_b32_dpp v21, v36, v5 row_newbcast:13 row_mask:0xf bank_mask:0xf
    v_and_b32_dpp v22, v36, v6 row_newbcast:13 row_mask:0xf bank_mask:0xf
    v_and_b32_dpp v23, v36, v7 row_newbcast:13 row_mask:0xf bank_mask:0xf
    v_mfma_f32_16x16x32_bf16 v[32:35], v[12:15], v[116:119], v[32:35]
    s_waitcnt vmcnt(5)
    s_cmp_ge_u32 s93, 16
    s_cbranch_scc1 L_d141
    s_waitcnt vmcnt(4)
L_d141:
    buffer_load_dwordx4 v[148:151], v2, s[40:43], s45 offen offset:1024 nt
    v_and_b32_dpp v8, v36, v4 row_newbcast:2 row_mask:0xf bank_mask:0xf
    v_and_b32_dpp v9, v36, v5 row_newbcast:2 row_mask:0xf bank_mask:0xf
    v_and_b32_dpp v10, v36, v6 row_newbcast:2 row_mask:0xf bank_mask:0xf
    v_and_b32_dpp v11, v36, v7 row_newbcast:2 row_mask:0xf bank_mask:0xf
    v_mfma_f32_16x16x32_bf16 v[32:35], v[16:19], v[120:123], v[32:35]
    v_and_b32_dpp v12, v36, v4 row_newbcast:6 row_mask:0xf bank_mask:0xf
    v_and_b32_dpp v13, v36, v5 row_newbcast:6 row_mask:0xf bank_mask:0xf
    v_and_b32_dpp v14, v36, v6 row_newbcast:6 row_mask:0xf bank_mask:0xf
    v_and_b32_dpp v15, v36, v7 row_newbcast:6 row_mask:0xf bank_mask:0xf
    v_mfma_f32_16x16x32_bf16 v[32:35], v[20:23], v[124:127], v[32:35]
    v_and_b32_dpp v16, v36, v4 row_newbcast:10 row_mask:0xf bank_mask:0xf
    v_and_b32_dpp v17, v36, v5 row_newbcast:10 row_mask:0xf bank_mask:0xf
    v_and_b32_dpp v18, v36, v6 row_newbcast:10 row_mask:0xf bank_mask:0xf
    v_and_b32_dpp v19, v36, v7 row_newbcast:10 row_mask:0xf bank_mask:0xf
    s_waitcnt vmcnt(5)
    s_cmp_ge_u32 s93, 16
    s_cbranch_scc1 L_d142
    s_waitcnt vmcnt(4)
L_d142:
    buffer_load_dwordx4 v[152:155], v2, s[40:43], s45 offen offset:2048 nt
    s_mov_b32 s32, 859136
    buffer_load_dword v47, v48, s[48:51], s32 offen nt
    v_mfma_f32_16x16x32_bf16 v[32:35], v[8:11], v[128:131], v[32:35]
    v_and_b32_dpp v20, v36, v4 row_newbcast:14 row_mask:0xf bank_mask:0xf
    v_and_b32_dpp v21, v36, v5 row_newbcast:14 row_mask:0xf bank_mask:0xf
    v_and_b32_dpp v22, v36, v6 row_newbcast:14 row_mask:0xf bank_mask:0xf
    v_and_b32_dpp v23, v36, v7 row_newbcast:14 row_mask:0xf bank_mask:0xf
    s_waitcnt vmcnt(6)
    s_cmp_ge_u32 s93, 16
    s_cbranch_scc1 L_d143
    s_waitcnt vmcnt(5)
L_d143:
    buffer_load_dwordx4 v[156:159], v2, s[40:43], s45 offen offset:3072 nt
    s_add_u32 s45, s45, 49152
    s_waitcnt vmcnt(6)
    s_cmp_ge_u32 s93, 16
    s_cbranch_scc1 L_d144
    s_waitcnt vmcnt(5)
L_d144:
    buffer_load_dwordx4 v[160:163], v2, s[40:43], s45 offen offset:0 nt
    s_mov_b32 s32, 859136
    buffer_store_dword v60, v49, s[48:51], s32 offen
    v_mfma_f32_16x16x32_bf16 v[32:35], v[12:15], v[132:135], v[32:35]
    v_and_b32_dpp v8, v36, v4 row_newbcast:3 row_mask:0xf bank_mask:0xf
    v_and_b32_dpp v9, v36, v5 row_newbcast:3 row_mask:0xf bank_mask:0xf
    v_and_b32_dpp v10, v36, v6 row_newbcast:3 row_mask:0xf bank_mask:0xf
    v_and_b32_dpp v11, v36, v7 row_newbcast:3 row_mask:0xf bank_mask:0xf
    s_waitcnt vmcnt(7)
    s_cmp_ge_u32 s93, 16
    s_cbranch_scc1 L_d145
    s_waitcnt vmcnt(6)
L_d145:
    buffer_load_dwordx4 v[164:167], v2, s[40:43], s45 offen offset:1024 nt
    s_waitcnt vmcnt(7)
    s_cmp_ge_u32 s93, 16
    s_cbranch_scc1 L_d146
    s_waitcnt vmcnt(6)
L_d146:
    buffer_load_dwordx4 v[168:171], v2, s[40:43], s45 offen offset:2048 nt
    v_mfma_f32_16x16x32_bf16 v[32:35], v[16:19], v[136:139], v[32:35]
    v_and_b32_dpp v12, v36, v4 row_newbcast:7 row_mask:0xf bank_mask:0xf
    v_and_b32_dpp v13, v36, v5 row_newbcast:7 row_mask:0xf bank_mask:0xf
    v_and_b32_dpp v14, v36, v6 row_newbcast:7 row_mask:0xf bank_mask:0xf
    v_and_b32_dpp v15, v36, v7 row_newbcast:7 row_mask:0xf bank_mask:0xf
    s_waitcnt vmcnt(7)
    s_cmp_ge_u32 s93, 16
    s_cbranch_scc1 L_d147
    s_waitcnt vmcnt(6)
    s_cmp_lt_i32 s95, -9
    s_cbranch_scc0 L_d147
    s_waitcnt vmcnt(4)
L_d147:
    buffer_load_dwordx4 v[172:175], v2, s[40:43], s45 offen offset:3072 nt
    s_add_u32 s45, s45, 16384
    v_mfma_f32_16x16x32_bf16 v[32:35], v[20:23], v[140:143], v[32:35]
    v_and_b32_dpp v16, v36, v4 row_newbcast:11 row_mask:0xf bank_mask:0xf
    v_and_b32_dpp v17, v36, v5 row_newbcast:11 row_mask:0xf bank_mask:0xf
    v_and_b32_dpp v18, v36, v6 row_newbcast:11 row_mask:0xf bank_mask:0xf
    v_and_b32_dpp v19, v36, v7 row_newbcast:11 row_mask:0xf bank_mask:0xf
    s_waitcnt vmcnt(7)
    s_cmp_ge_u32 s93, 16
    s_cbranch_scc1 L_d148
    s_waitcnt vmcnt(5)
L_d148:
    buffer_load_dwordx4 v[176:179], v2, s[40:43], s45 offen offset:0 nt
    v_mfma_f32_16x16x32_bf16 v[32:35], v[8:11], v[144:147], v[32:35]
    v_and_b32_dpp v20, v36, v4 row_newbcast:15 row_mask:0xf bank_mask:0xf
    v_and_b32_dpp v21, v36, v5 row_newbcast:15 row_mask:0xf bank_mask:0xf
    v_and_b32_dpp v22, v36, v6 row_newbcast:15 row_mask:0xf bank_mask:0xf
    v_and_b32_dpp v23, v36, v7 row_newbcast:15 row_mask:0xf bank_mask:0xf
    s_waitcnt vmcnt(6)
    s_cmp_ge_u32 s93, 16
    s_cbranch_scc1 L_d149
    s_waitcnt vmcnt(5)
L_d149:
    buffer_load_dwordx4 v[180:183], v2, s[40:43], s45 offen offset:1024 nt
    v_mfma_f32_16x16x32_bf16 v[32:35], v[12:15], v[148:151], v[32:35]
    v_and_b32_dpp v8, v37, v4 row_newbcast:0 row_mask:0xf bank_mask:0xf
    v_and_b32_dpp v9, v37, v5 row_newbcast:0 row_mask:0xf bank_mask:0xf
    v_and_b32_dpp v10, v37, v6 row_newbcast:0 row_mask:0xf bank_mask:0xf
    v_and_b32_dpp v11, v37, v7 row_newbcast:0 row_mask:0xf bank_mask:0xf
    v_mfma_f32_16x16x32_bf16 v[32:35], v[16:19], v[152:155], v[32:35]
    v_and_b32_dpp v12, v37, v4 row_newbcast:4 row_mask:0xf bank_mask:0xf
    v_and_b32_dpp v13, v37, v5 row_newbcast:4 row_mask:0xf bank_mask:0xf
    v_and_b32_dpp v14, v37, v6 row_newbcast:4 row_mask:0xf bank_mask:0xf
    v_and_b32_dpp v15, v37, v7 row_newbcast:4 row_mask:0xf bank_mask:0xf
    s_waitcnt vmcnt(6)
    s_cmp_ge_u32 s93, 16
    s_cbranch_scc1 L_d150
    s_waitcnt vmcnt(4)
L_d150:
    buffer_load_dwordx4 v[184:187], v2, s[40:43], s45 offen offset:2048 nt
    v_mfma_f32_16x16x32_bf16 v[32:35], v[20:23], v[156:159], v[32:35]
    v_and_b32_dpp v16, v37, v4 row_newbcast:8 row_mask:0xf bank_mask:0xf
    v_and_b32_dpp v17, v37, v5 row_newbcast:8 row_mask:0xf bank_mask:0xf
    v_and_b32_dpp v18, v37, v6 row_newbcast:8 row_mask:0xf bank_mask:0xf
    v_and_b32_dpp v19, v37, v7 row_newbcast:8 row_mask:0xf bank_mask:0xf
    s_waitcnt vmcnt(5)
    s_cmp_ge_u32 s93, 16
    s_cbranch_scc1 L_d151
    s_waitcnt vmcnt(4)
L_d151:
    buffer_load_dwordx4 v[188:191], v2, s[40:43], s45 offen offset:3072 nt
    s_add_u32 s45, s45, 49152
    v_cmp_eq_u32 vcc, v60, v47
    s_nop 0
    s_bcnt1_i32_b64 s93, vcc
    v_mfma_f32_16x16x32_bf16 v[32:35], v[8:11], v[160:163], v[32:35]
    v_and_b32_dpp v20, v37, v4 row_newbcast:12 row_mask:0xf bank_mask:0xf
    v_and_b32_dpp v21, v37, v5 row_newbcast:12 row_mask:0xf bank_mask:0xf
    v_and_b32_dpp v22, v37, v6 row_newbcast:12 row_mask:0xf bank_mask:0xf
    v_and_b32_dpp v23, v37, v7 row_newbcast:12 row_mask:0xf bank_mask:0xf
    v_mfma_f32_16x16x32_bf16 v[32:35], v[12:15], v[164:167], v[32:35]
    v_and_b32_dpp v8, v37, v4 row_newbcast:1 row_mask:0xf bank_mask:0xf
    v_and_b32_dpp v9, v37, v5 row_newbcast:1 row_mask:0xf bank_mask:0xf
    v_and_b32_dpp v10, v37, v6 row_newbcast:1 row_mask:0xf bank_mask:0xf
    v_and_b32_dpp v11, v37, v7 row_newbcast:1 row_mask:0xf bank_mask:0xf
    s_waitcnt vmcnt(5)
    s_cmp_ge_u32 s93, 16
    s_cbranch_scc1 L_d152
    s_waitcnt vmcnt(4)
L_d152:
    buffer_load_dwordx4 v[192:195], v2, s[40:43], s45 offen offset:0 nt
    v_mfma_f32_16x16x32_bf16 v[32:35], v[16:19], v[168:171], v[32:35]
    v_and_b32_dpp v12, v37, v4 row_newbcast:5 row_mask:0xf bank_mask:0xf
    v_and_b32_dpp v13, v37, v5 row_newbcast:5 row_mask:0xf bank_mask:0xf
    v_and_b32_dpp v14, v37, v6 row_newbcast:5 row_mask:0xf bank_mask:0xf
    v_and_b32_dpp v15, v37, v7 row_newbcast:5 row_mask:0xf bank_mask:0xf
    s_waitcnt vmcnt(5)
    s_cmp_ge_u32 s93, 16
    s_cbranch_scc1 L_d153
    s_waitcnt vmcnt(4)
L_d153:
    buffer_load_dwordx4 v[196:199], v2, s[40:43], s45 offen offset:1024 nt
    v_mfma_f32_16x16x32_bf16 v[32:35], v[20:23], v[172:175], v[32:35]
    v_and_b32_dpp v16, v37, v4 row_newbcast:9 row_mask:0xf bank_mask:0xf
    v_and_b32_dpp v17, v37, v5 row_newbcast:9 row_mask:0xf bank_mask:0xf
    v_and_b32_dpp v18, v37, v6 row_newbcast:9 row_mask:0xf bank_mask:0xf
    v_and_b32_dpp v19, v37, v7 row_newbcast:9 row_mask:0xf bank_mask:0xf
    s_waitcnt vmcnt(5)
    s_cmp_ge_u32 s93, 16
    s_cbranch_scc1 L_d154
    s_waitcnt vmcnt(4)
L_d154:
    buffer_load_dwordx4 v[200:203], v2, s[40:43], s45 offen offset:2048 nt
    v_mfma_f32_16x16x32_bf16 v[32:35], v[8:11], v[176:179], v[32:35]
    v_and_b32_dpp v20, v37, v4 row_newbcast:13 row_mask:0xf bank_mask:0xf
    v_and_b32_dpp v21, v37, v5 row_newbcast:13 row_mask:0xf bank_mask:0xf
    v_and_b32_dpp v22, v37, v6 row_newbcast:13 row_mask:0xf bank_mask:0xf
    v_and_b32_dpp v23, v37, v7 row_newbcast:13 row_mask:0xf bank_mask:0xf
    s_waitcnt vmcnt(5)
    s_cmp_ge_u32 s93, 16
    s_cbranch_scc1 L_d155
    s_waitcnt vmcnt(4)
L_d155:
    buffer_load_dwordx4 v[204:207], v2, s[40:43], s45 offen offset:3072 nt
    s_add_u32 s45, s45, 16384
    v_mfma_f32_16x16x32_bf16 v[32:35], v[12:15], v[180:183], v[32:35]
    v_and_b32_dpp v8, v37, v4 row_newbcast:2 row_mask:0xf bank_mask:0xf
    v_and_b32_dpp v9, v37, v5 row_newbcast:2 row_mask:0xf bank_mask:0xf
    v_and_b32_dpp v10, v37, v6 row_newbcast:2 row_mask:0xf bank_mask:0xf
    v_and_b32_dpp v11, v37, v7 row_newbcast:2 row_mask:0xf bank_mask:0xf
    s_waitcnt vmcnt(5)
    s_cmp_ge_u32 s93, 16
    s_cbranch_scc1 L_d156
    s_waitcnt vmcnt(4)
L_d156:
    buffer_load_dwordx4 v[208:211], v2, s[40:43], s45 offen offset:0 nt
    v_mfma_f32_16x16x32_bf16 v[32:35], v[16:19], v[184:187], v[32:35]
    v_and_b32_dpp v12, v37, v4 row_newbcast:6 row_mask:0xf bank_mask:0xf
    v_and_b32_dpp v13, v37, v5 row_newbcast:6 row_mask:0xf bank_mask:0xf
    v_and_b32_dpp v14, v37, v6 row_newbcast:6 row_mask:0xf bank_mask:0xf
    v_and_b32_dpp v15, v37, v7 row_newbcast:6 row_mask:0xf bank_mask:0xf
    s_waitcnt vmcnt(5)
    s_cmp_ge_u32 s93, 16
    s_cbranch_scc1 L_d157
    s_waitcnt vmcnt(4)
L_d157:
    buffer_load_dwordx4 v[212:215], v2, s[40:43], s45 offen offset:1024 nt
    v_mfma_f32_16x16x32_bf16 v[32:35], v[20:23], v[188:191], v[32:35]
    v_and_b32_dpp v16, v37, v4 row_newbcast:10 row_mask:0xf bank_mask:0xf
    v_and_b32_dpp v17, v37, v5 row_newbcast:10 row_mask:0xf bank_mask:0xf
    v_and_b32_dpp v18, v37, v6 row_newbcast:10 row_mask:0xf bank_mask:0xf
    v_and_b32_dpp v19, v37, v7 row_newbcast:10 row_mask:0xf bank_mask:0xf
    s_waitcnt vmcnt(5)
    s_cmp_ge_u32 s93, 16
    s_cbranch_scc1 L_d158
    s_waitcnt vmcnt(4)
L_d158:
    buffer_load_dwordx4 v[216:219], v2, s[40:43], s45 offen offset:2048 nt
    s_mov_b32 s32, 860160
    buffer_load_dword v54, v48, s[48:51], s32 offen nt
    v_mfma_f32_16x16x32_bf16 v[32:35], v[8:11], v[192:195], v[32:35]
    v_and_b32_dpp v20, v37, v4 row_newbcast:14 row_mask:0xf bank_mask:0xf
    v_and_b32_dpp v21, v37, v5 row_newbcast:14 row_mask:0xf bank_mask:0xf
    v_and_b32_dpp v22, v37, v6 row_newbcast:14 row_mask:0xf bank_mask:0xf
    v_and_b32_dpp v23, v37, v7 row_newbcast:14 row_mask:0xf bank_mask:0xf
    s_waitcnt vmcnt(6)
    s_cmp_ge_u32 s93, 16
    s_cbranch_scc1 L_d159
    s_waitcnt vmcnt(5)
L_d159:
    buffer_load_dwordx4 v[220:223], v2, s[40:43], s45 offen offset:3072 nt
    s_add_u32 s45, s45, 49152
    s_waitcnt vmcnt(6)
    s_cmp_ge_u32 s93, 16
    s_cbranch_scc1 L_d160
    s_waitcnt vmcnt(5)
L_d160:
    buffer_load_dwordx4 v[224:227], v2, s[40:43], s45 offen offset:0 nt
    s_mov_b32 s32, 860160
    buffer_store_dword v60, v49, s[48:51], s32 offen
    v_mfma_f32_16x16x32_bf16 v[32:35], v[12:15], v[196:199], v[32:35]
    v_and_b32_dpp v8, v37, v4 row_newbcast:3 row_mask:0xf bank_mask:0xf
    v_and_b32_dpp v9, v37, v5 row_newbcast:3 row_mask:0xf bank_mask:0xf
    v_and_b32_dpp v10, v37, v6 row_newbcast:3 row_mask:0xf bank_mask:0xf
    v_and_b32_dpp v11, v37, v7 row_newbcast:3 row_mask:0xf bank_mask:0xf
    s_waitcnt vmcnt(7)
    s_cmp_ge_u32 s93, 16
    s_cbranch_scc1 L_d161
    s_waitcnt vmcnt(6)
L_d161:
    buffer_load_dwordx4 v[228:231], v2, s[40:43], s45 offen offset:1024 nt
    s_waitcnt vmcnt(7)
    s_cmp_ge_u32 s93, 16
    s_cbranch_scc1 L_d162
    s_waitcnt vmcnt(6)
L_d162:
    buffer_load_dwordx4 v[232:235], v2, s[40:43], s45 offen offset:2048 nt
    v_mfma_f32_16x16x32_bf16 v[32:35], v[16:19], v[200:203], v[32:35]
    v_and_b32_dpp v12, v37, v4 row_newbcast:7 row_mask:0xf bank_mask:0xf
    v_and_b32_dpp v13, v37, v5 row_newbcast:7 row_mask:0xf bank_mask:0xf
    v_and_b32_dpp v14, v37, v6 row_newbcast:7 row_mask:0xf bank_mask:0xf
    v_and_b32_dpp v15, v37, v7 row_newbcast:7 row_mask:0xf bank_mask:0xf
    s_waitcnt vmcnt(7)
    s_cmp_ge_u32 s93, 16
    s_cbranch_scc1 L_d163
    s_waitcnt vmcnt(6)
    s_cmp_lt_i32 s95, -5
    s_cbranch_scc0 L_d163
    s_waitcnt vmcnt(4)
L_d163:
    buffer_load_dwordx4 v[236:239], v2, s[40:43], s45 offen offset:3072 nt
    s_add_u32 s45, s45, 16384
    v_mfma_f32_16x16x32_bf16 v[32:35], v[20:23], v[204:207], v[32:35]
    v_and_b32_dpp v16, v37, v4 row_newbcast:11 row_mask:0xf bank_mask:0xf
    v_and_b32_dpp v17, v37, v5 row_newbcast:11 row_mask:0xf bank_mask:0xf
    v_and_b32_dpp v18, v37, v6 row_newbcast:11 row_mask:0xf bank_mask:0xf
    v_and_b32_dpp v19, v37, v7 row_newbcast:11 row_mask:0xf bank_mask:0xf
    s_waitcnt vmcnt(7)
    s_cmp_ge_u32 s93, 16
    s_cbranch_scc1 L_d164
    s_waitcnt vmcnt(5)
L_d164:
    buffer_load_dwordx4 v[240:243], v2, s[40:43], s45 offen offset:0 nt
    v_mfma_f32_16x16x32_bf16 v[32:35], v[8:11], v[208:211], v[32:35]
    v_and_b32_dpp v20, v37, v4 row_newbcast:15 row_mask:0xf bank_mask:0xf
    v_and_b32_dpp v21, v37, v5 row_newbcast:15 row_mask:0xf bank_mask:0xf
    v_and_b32_dpp v22, v37, v6 row_newbcast:15 row_mask:0xf bank_mask:0xf
    v_and_b32_dpp v23, v37, v7 row_newbcast:15 row_mask:0xf bank_mask:0xf
    s_waitcnt vmcnt(6)
    s_cmp_ge_u32 s93, 16
    s_cbranch_scc1 L_d165
    s_waitcnt vmcnt(5)
L_d165:
    buffer_load_dwordx4 v[244:247], v2, s[40:43], s45 offen offset:1024 nt
    v_mfma_f32_16x16x32_bf16 v[32:35], v[12:15], v[212:215], v[32:35]
    v_and_b32_dpp v8, v38, v4 row_newbcast:0 row_mask:0xf bank_mask:0xf
    v_and_b32_dpp v9, v38, v5 row_newbcast:0 row_mask:0xf bank_mask:0xf
    v_and_b32_dpp v10, v38, v6 row_newbcast:0 row_mask:0xf bank_mask:0xf
    v_and_b32_dpp v11, v38, v7 row_newbcast:0 row_mask:0xf bank_mask:0xf
    v_mfma_f32_16x16x32_bf16 v[32:35], v[16:19], v[216:219], v[32:35]
    v_and_b32_dpp v12, v38, v4 row_newbcast:4 row_mask:0xf bank_mask:0xf
    v_and_b32_dpp v13, v38, v5 row_newbcast:4 row_mask:0xf bank_mask:0xf
    v_and_b32_dpp v14, v38, v6 row_newbcast:4 row_mask:0xf bank_mask:0xf
    v_and_b32_dpp v15, v38, v7 row_newbcast:4 row_mask:0xf bank_mask:0xf
    s_waitcnt vmcnt(6)
    s_cmp_ge_u32 s93, 16
    s_cbranch_scc1 L_d166
    s_waitcnt vmcnt(4)
L_d166:
    buffer_load_dwordx4 v[248:251], v2, s[40:43], s45 offen offset:2048 nt
    v_mfma_f32_16x16x32_bf16 v[32:35], v[20:23], v[220:223], v[32:35]
    v_and_b32_dpp v16, v38, v4 row_newbcast:8 row_mask:0xf bank_mask:0xf
    v_and_b32_dpp v17, v38, v5 row_newbcast:8 row_mask:0xf bank_mask:0xf
    v_and_b32_dpp v18, v38, v6 row_newbcast:8 row_mask:0xf bank_mask:0xf
    v_and_b32_dpp v19, v38, v7 row_newbcast:8 row_mask:0xf bank_mask:0xf
    s_waitcnt vmcnt(5)
    s_cmp_ge_u32 s93, 16
    s_cbranch_scc1 L_d167
    s_waitcnt vmcnt(4)
L_d167:
    buffer_load_dwordx4 v[252:255], v2, s[40:43], s45 offen offset:3072 nt
    s_add_u32 s45, s45, 49152
    v_cmp_eq_u32 vcc, v60, v54
    s_nop 0
    s_bcnt1_i32_b64 s93, vcc
    v_mfma_f32_16x16x32_bf16 v[32:35], v[8:11], v[224:227], v[32:35]
    v_and_b32_dpp v20, v38, v4 row_newbcast:12 row_mask:0xf bank_mask:0xf
    v_and_b32_dpp v21, v38, v5 row_newbcast:12 row_mask:0xf bank_mask:0xf
    v_and_b32_dpp v22, v38, v6 row_newbcast:12 row_mask:0xf bank_mask:0xf
    v_and_b32_dpp v23, v38, v7 row_newbcast:12 row_mask:0xf bank_mask:0xf
    v_mfma_f32_16x16x32_bf16 v[32:35], v[12:15], v[228:231], v[32:35]
    v_and_b32_dpp v8, v38, v4 row_newbcast:1 row_mask:0xf bank_mask:0xf
    v_and_b32_dpp v9, v38, v5 row_newbcast:1 row_mask:0xf bank_mask:0xf
    v_and_b32_dpp v10, v38, v6 row_newbcast:1 row_mask:0xf bank_mask:0xf
    v_and_b32_dpp v11, v38, v7 row_newbcast:1 row_mask:0xf bank_mask:0xf
    s_waitcnt vmcnt(5)
    s_cmp_ge_u32 s93, 16
    s_cbranch_scc1 L_d168
    s_waitcnt vmcnt(4)
L_d168:
    buffer_load_dwordx4 v[64:67], v2, s[40:43], s45 offen offset:0 nt
    v_mfma_f32_16x16x32_bf16 v[32:35], v[16:19], v[232:235], v[32:35]
    v_and_b32_dpp v12, v38, v4 row_newbcast:5 row_mask:0xf bank_mask:0xf
    v_and_b32_dpp v13, v38, v5 row_newbcast:5 row_mask:0xf bank_mask:0xf
    v_and_b32_dpp v14, v38, v6 row_newbcast:5 row_mask:0xf bank_mask:0xf
    v_and_b32_dpp v15, v38, v7 row_newbcast:5 row_mask:0xf bank_mask:0xf
    s_waitcnt vmcnt(5)
    s_cmp_ge_u32 s93, 16
    s_cbranch_scc1 L_d169
    s_waitcnt vmcnt(4)
L_d169:
    buffer_load_dwordx4 v[68:71], v2, s[40:43], s45 offen offset:1024 nt
    v_mfma_f32_16x16x32_bf16 v[32:35], v[20:23], v[236:239], v[32:35]
    v_and_b32_dpp v16, v38, v4 row_newbcast:9 row_mask:0xf bank_mask:0xf
    v_and_b32_dpp v17, v38, v5 row_newbcast:9 row_mask:0xf bank_mask:0xf
    v_and_b32_dpp v18, v38, v6 row_newbcast:9 row_mask:0xf bank_mask:0xf
    v_and_b32_dpp v19, v38, v7 row_newbcast:9 row_mask:0xf bank_mask:0xf
    s_waitcnt vmcnt(5)
    s_cmp_ge_u32 s93, 16
    s_cbranch_scc1 L_d170
    s_waitcnt vmcnt(4)
L_d170:
    buffer_load_dwordx4 v[72:75], v2, s[40:43], s45 offen offset:2048 nt
    v_mfma_f32_16x16x32_bf16 v[32:35], v[8:11], v[240:243], v[32:35]
    v_and_b32_dpp v20, v38, v4 row_newbcast:13 row_mask:0xf bank_mask:0xf
    v_and_b32_dpp v21, v38, v5 row_newbcast:13 row_mask:0xf bank_mask:0xf
    v_and_b32_dpp v22, v38, v6 row_newbcast:13 row_mask:0xf bank_mask:0xf
    v_and_b32_dpp v23, v38, v7 row_newbcast:13 row_mask:0xf bank_mask:0xf
    s_waitcnt vmcnt(5)
    s_cmp_ge_u32 s93, 16
    s_cbranch_scc1 L_d171
    s_waitcnt vmcnt(4)
L_d171:
    buffer_load_dwordx4 v[76:79], v2, s[40:43], s45 offen offset:3072 nt
    s_add_u32 s45, s45, 16384
    v_mfma_f32_16x16x32_bf16 v[32:35], v[12:15], v[244:247], v[32:35]
    v_and_b32_dpp v8, v38, v4 row_newbcast:2 row_mask:0xf bank_mask:0xf
    v_and_b32_dpp v9, v38, v5 row_newbcast:2 row_mask:0xf bank_mask:0xf
    v_and_b32_dpp v10, v38, v6 row_newbcast:2 row_mask:0xf bank_mask:0xf
    v_and_b32_dpp v11, v38, v7 row_newbcast:2 row_mask:0xf bank_mask:0xf
    s_waitcnt vmcnt(5)
    s_cmp_ge_u32 s93, 16
    s_cbranch_scc1 L_d172
    s_waitcnt vmcnt(4)
L_d172:
    buffer_load_dwordx4 v[80:83], v2, s[40:43], s45 offen offset:0 nt
    v_mfma_f32_16x16x32_bf16 v[32:35], v[16:19], v[248:251], v[32:35]
    v_and_b32_dpp v12, v38, v4 row_newbcast:6 row_mask:0xf bank_mask:0xf
    v_and_b32_dpp v13, v38, v5 row_newbcast:6 row_mask:0xf bank_mask:0xf
    v_and_b32_dpp v14, v38, v6 row_newbcast:6 row_mask:0xf bank_mask:0xf
    v_and_b32_dpp v15, v38, v7 row_newbcast:6 row_mask:0xf bank_mask:0xf
    s_waitcnt vmcnt(5)
    s_cmp_ge_u32 s93, 16
    s_cbranch_scc1 L_d173
    s_waitcnt vmcnt(4)
L_d173:
    buffer_load_dwordx4 v[84:87], v2, s[40:43], s45 offen offset:1024 nt
    v_mfma_f32_16x16x32_bf16 v[32:35], v[20:23], v[252:255], v[32:35]
    v_and_b32_dpp v16, v38, v4 row_newbcast:10 row_mask:0xf bank_mask:0xf
    v_and_b32_dpp v17, v38, v5 row_newbcast:10 row_mask:0xf bank_mask:0xf
    v_and_b32_dpp v18, v38, v6 row_newbcast:10 row_mask:0xf bank_mask:0xf
    v_and_b32_dpp v19, v38, v7 row_newbcast:10 row_mask:0xf bank_mask:0xf
    s_waitcnt vmcnt(5)
    s_cmp_ge_u32 s93, 16
    s_cbranch_scc1 L_d174
    s_waitcnt vmcnt(4)
L_d174:
    buffer_load_dwordx4 v[88:91], v2, s[40:43], s45 offen offset:2048 nt
    s_mov_b32 s32, 861184
    buffer_load_dword v47, v48, s[48:51], s32 offen nt
    v_mfma_f32_16x16x32_bf16 v[32:35], v[8:11], v[64:67], v[32:35]
    v_and_b32_dpp v20, v38, v4 row_newbcast:14 row_mask:0xf bank_mask:0xf
    v_and_b32_dpp v21, v38, v5 row_newbcast:14 row_mask:0xf bank_mask:0xf
    v_and_b32_dpp v22, v38, v6 row_newbcast:14 row_mask:0xf bank_mask:0xf
    v_and_b32_dpp v23, v38, v7 row_newbcast:14 row_mask:0xf bank_mask:0xf
    s_waitcnt vmcnt(6)
    s_cmp_ge_u32 s93, 16
    s_cbranch_scc1 L_d175
    s_waitcnt vmcnt(5)
L_d175:
    buffer_load_dwordx4 v[92:95], v2, s[40:43], s45 offen offset:3072 nt
    s_add_u32 s45, s45, 49152
    s_waitcnt vmcnt(6)
    s_cmp_ge_u32 s93, 16
    s_cbranch_scc1 L_d176
    s_waitcnt vmcnt(5)
L_d176:
    buffer_load_dwordx4 v[96:99], v2, s[40:43], s45 offen offset:0 nt
    s_mov_b32 s32, 861184
    buffer_store_dword v60, v49, s[48:51], s32 offen
    v_mfma_f32_16x16x32_bf16 v[32:35], v[12:15], v[68:71], v[32:35]
    v_and_b32_dpp v8, v38, v4 row_newbcast:3 row_mask:0xf bank_mask:0xf
    v_and_b32_dpp v9, v38, v5 row_newbcast:3 row_mask:0xf bank_mask:0xf
    v_and_b32_dpp v10, v38, v6 row_newbcast:3 row_mask:0xf bank_mask:0xf
    v_and_b32_dpp v11, v38, v7 row_newbcast:3 row_mask:0xf bank_mask:0xf
    s_waitcnt vmcnt(7)
    s_cmp_ge_u32 s93, 16
    s_cbranch_scc1 L_d177
    s_waitcnt vmcnt(6)
L_d177:
    buffer_load_dwordx4 v[100:103], v2, s[40:43], s45 offen offset:1024 nt
    s_waitcnt vmcnt(7)
    s_cmp_ge_u32 s93, 16
    s_cbranch_scc1 L_d178
    s_waitcnt vmcnt(6)
L_d178:
    buffer_load_dwordx4 v[104:107], v2, s[40:43], s45 offen offset:2048 nt
    v_mfma_f32_16x16x32_bf16 v[32:35], v[16:19], v[72:75], v[32:35]
    v_and_b32_dpp v12, v38, v4 row_newbcast:7 row_mask:0xf bank_mask:0xf
    v_and_b32_dpp v13, v38, v5 row_newbcast:7 row_mask:0xf bank_mask:0xf
    v_and_b32_dpp v14, v38, v6 row_newbcast:7 row_mask:0xf bank_mask:0xf
    v_and_b32_dpp v15, v38, v7 row_newbcast:7 row_mask:0xf bank_mask:0xf
    s_waitcnt vmcnt(7)
    s_cmp_ge_u32 s93, 16
    s_cbranch_scc1 L_d179
    s_waitcnt vmcnt(6)
    s_cmp_lt_i32 s95, -13
    s_cbranch_scc0 L_d179
    s_waitcnt vmcnt(4)
L_d179:
    buffer_load_dwordx4 v[108:111], v2, s[40:43], s45 offen offset:3072 nt
    s_add_u32 s45, s45, 16384
    v_mfma_f32_16x16x32_bf16 v[32:35], v[20:23], v[76:79], v[32:35]
    v_and_b32_dpp v16, v38, v4 row_newbcast:11 row_mask:0xf bank_mask:0xf
    v_and_b32_dpp v17, v38, v5 row_newbcast:11 row_mask:0xf bank_mask:0xf
    v_and_b32_dpp v18, v38, v6 row_newbcast:11 row_mask:0xf bank_mask:0xf
    v_and_b32_dpp v19, v38, v7 row_newbcast:11 row_mask:0xf bank_mask:0xf
    s_waitcnt vmcnt(7)
    s_cmp_ge_u32 s93, 16
    s_cbranch_scc1 L_d180
    s_waitcnt vmcnt(5)
L_d180:
    buffer_load_dwordx4 v[112:115], v2, s[40:43], s45 offen offset:0 nt
    v_mfma_f32_16x16x32_bf16 v[32:35], v[8:11], v[80:83], v[32:35]
    v_and_b32_dpp v20, v38, v4 row_newbcast:15 row_mask:0xf bank_mask:0xf
    v_and_b32_dpp v21, v38, v5 row_newbcast:15 row_mask:0xf bank_mask:0xf
    v_and_b32_dpp v22, v38, v6 row_newbcast:15 row_mask:0xf bank_mask:0xf
    v_and_b32_dpp v23, v38, v7 row_newbcast:15 row_mask:0xf bank_mask:0xf
    s_waitcnt vmcnt(6)
    s_cmp_ge_u32 s93, 16
    s_cbranch_scc1 L_d181
    s_waitcnt vmcnt(5)
L_d181:
    buffer_load_dwordx4 v[116:119], v2, s[40:43], s45 offen offset:1024 nt
    v_mfma_f32_16x16x32_bf16 v[32:35], v[12:15], v[84:87], v[32:35]
    v_and_b32_dpp v8, v39, v4 row_newbcast:0 row_mask:0xf bank_mask:0xf
    v_and_b32_dpp v9, v39, v5 row_newbcast:0 row_mask:0xf bank_mask:0xf
    v_and_b32_dpp v10, v39, v6 row_newbcast:0 row_mask:0xf bank_mask:0xf
    v_and_b32_dpp v11, v39, v7 row_newbcast:0 row_mask:0xf bank_mask:0xf
    v_mfma_f32_16x16x32_bf16 v[32:35], v[16:19], v[88:91], v[32:35]
    v_and_b32_dpp v12, v39, v4 row_newbcast:4 row_mask:0xf bank_mask:0xf
    v_and_b32_dpp v13, v39, v5 row_newbcast:4 row_mask:0xf bank_mask:0xf
    v_and_b32_dpp v14, v39, v6 row_newbcast:4 row_mask:0xf bank_mask:0xf
    v_and_b32_dpp v15, v39, v7 row_newbcast:4 row_mask:0xf bank_mask:0xf
    s_waitcnt vmcnt(6)
    s_cmp_ge_u32 s93, 16
    s_cbranch_scc1 L_d182
    s_waitcnt vmcnt(4)
L_d182:
    buffer_load_dwordx4 v[120:123], v2, s[40:43], s45 offen offset:2048 nt
    v_mfma_f32_16x16x32_bf16 v[32:35], v[20:23], v[92:95], v[32:35]
    v_and_b32_dpp v16, v39, v4 row_newbcast:8 row_mask:0xf bank_mask:0xf
    v_and_b32_dpp v17, v39, v5 row_newbcast:8 row_mask:0xf bank_mask:0xf
    v_and_b32_dpp v18, v39, v6 row_newbcast:8 row_mask:0xf bank_mask:0xf
    v_and_b32_dpp v19, v39, v7 row_newbcast:8 row_mask:0xf bank_mask:0xf
    s_waitcnt vmcnt(5)
    s_cmp_ge_u32 s93, 16
    s_cbranch_scc1 L_d183
    s_waitcnt vmcnt(4)
L_d183:
    buffer_load_dwordx4 v[124:127], v2, s[40:43], s45 offen offset:3072 nt
    s_add_u32 s45, s45, 49152
    v_cmp_eq_u32 vcc, v60, v47
    s_nop 0
    s_bcnt1_i32_b64 s93, vcc
    v_mfma_f32_16x16x32_bf16 v[32:35], v[8:11], v[96:99], v[32:35]
    v_and_b32_dpp v20, v39, v4 row_newbcast:12 row_mask:0xf bank_mask:0xf
    v_and_b32_dpp v21, v39, v5 row_newbcast:12 row_mask:0xf bank_mask:0xf
    v_and_b32_dpp v22, v39, v6 row_newbcast:12 row_mask:0xf bank_mask:0xf
    v_and_b32_dpp v23, v39, v7 row_newbcast:12 row_mask:0xf bank_mask:0xf
    v_mfma_f32_16x16x32_bf16 v[32:35], v[12:15], v[100:103], v[32:35]
    v_and_b32_dpp v8, v39, v4 row_newbcast:1 row_mask:0xf bank_mask:0xf
    v_and_b32_dpp v9, v39, v5 row_newbcast:1 row_mask:0xf bank_mask:0xf
    v_and_b32_dpp v10, v39, v6 row_newbcast:1 row_mask:0xf bank_mask:0xf
    v_and_b32_dpp v11, v39, v7 row_newbcast:1 row_mask:0xf bank_mask:0xf
    s_waitcnt vmcnt(5)
    s_cmp_ge_u32 s93, 16
    s_cbranch_scc1 L_d184
    s_waitcnt vmcnt(4)
L_d184:
    buffer_load_dwordx4 v[128:131], v2, s[40:43], s45 offen offset:0 nt
    v_mfma_f32_16x16x32_bf16 v[32:35], v[16:19], v[104:107], v[32:35]
    v_and_b32_dpp v12, v39, v4 row_newbcast:5 row_mask:0xf bank_mask:0xf
    v_and_b32_dpp v13, v39, v5 row_newbcast:5 row_mask:0xf bank_mask:0xf
    v_and_b32_dpp v14, v39, v6 row_newbcast:5 row_mask:0xf bank_mask:0xf
    v_and_b32_dpp v15, v39, v7 row_newbcast:5 row_mask:0xf bank_mask:0xf
    s_waitcnt vmcnt(5)
    s_cmp_ge_u32 s93, 16
    s_cbranch_scc1 L_d185
    s_waitcnt vmcnt(4)
L_d185:
    buffer_load_dwordx4 v[132:135], v2, s[40:43], s45 offen offset:1024 nt
    v_mfma_f32_16x16x32_bf16 v[32:35], v[20:23], v[108:111], v[32:35]
    v_and_b32_dpp v16, v39, v4 row_newbcast:9 row_mask:0xf bank_mask:0xf
    v_and_b32_dpp v17, v39, v5 row_newbcast:9 row_mask:0xf bank_mask:0xf
    v_and_b32_dpp v18, v39, v6 row_newbcast:9 row_mask:0xf bank_mask:0xf
    v_and_b32_dpp v19, v39, v7 row_newbcast:9 row_mask:0xf bank_mask:0xf
    s_waitcnt vmcnt(5)
    s_cmp_ge_u32 s93, 16
    s_cbranch_scc1 L_d186
    s_waitcnt vmcnt(4)
L_d186:
    buffer_load_dwordx4 v[136:139], v2, s[40:43], s45 offen offset:2048 nt
    v_mfma_f32_16x16x32_bf16 v[32:35], v[8:11], v[112:115], v[32:35]
    v_and_b32_dpp v20, v39, v4 row_newbcast:13 row_mask:0xf bank_mask:0xf
    v_and_b32_dpp v21, v39, v5 row_newbcast:13 row_mask:0xf bank_mask:0xf
    v_and_b32_dpp v22, v39, v6 row_newbcast:13 row_mask:0xf bank_mask:0xf
    v_and_b32_dpp v23, v39, v7 row_newbcast:13 row_mask:0xf bank_mask:0xf
    s_waitcnt vmcnt(5)
    s_cmp_ge_u32 s93, 16
    s_cbranch_scc1 L_d187
    s_waitcnt vmcnt(4)
L_d187:
    buffer_load_dwordx4 v[140:143], v2, s[40:43], s45 offen offset:3072 nt
    s_add_u32 s45, s45, 16384
    v_mfma_f32_16x16x32_bf16 v[32:35], v[12:15], v[116:119], v[32:35]
    v_and_b32_dpp v8, v39, v4 row_newbcast:2 row_mask:0xf bank_mask:0xf
    v_and_b32_dpp v9, v39, v5 row_newbcast:2 row_mask:0xf bank_mask:0xf
    v_and_b32_dpp v10, v39, v6 row_newbcast:2 row_mask:0xf bank_mask:0xf
    v_and_b32_dpp v11, v39, v7 row_newbcast:2 row_mask:0xf bank_mask:0xf
    s_waitcnt vmcnt(5)
    s_cmp_ge_u32 s93, 16
    s_cbranch_scc1 L_d188
    s_waitcnt vmcnt(4)
L_d188:
    buffer_load_dwordx4 v[144:147], v2, s[40:43], s45 offen offset:0 nt
    v_mfma_f32_16x16x32_bf16 v[32:35], v[16:19], v[120:123], v[32:35]
    v_and_b32_dpp v12, v39, v4 row_newbcast:6 row_mask:0xf bank_mask:0xf
    v_and_b32_dpp v13, v39, v5 row_newbcast:6 row_mask:0xf bank_mask:0xf
    v_and_b32_dpp v14, v39, v6 row_newbcast:6 row_mask:0xf bank_mask:0xf
    v_and_b32_dpp v15, v39, v7 row_newbcast:6 row_mask:0xf bank_mask:0xf
    s_waitcnt vmcnt(5)
    s_cmp_ge_u32 s93, 16
    s_cbranch_scc1 L_d189
    s_waitcnt vmcnt(4)
L_d189:
    buffer_load_dwordx4 v[148:151], v2, s[40:43], s45 offen offset:1024 nt
    v_mfma_f32_16x16x32_bf16 v[32:35], v[20:23], v[124:127], v[32:35]
    v_and_b32_dpp v16, v39, v4 row_newbcast:10 row_mask:0xf bank_mask:0xf
    v_and_b32_dpp v17, v39, v5 row_newbcast:10 row_mask:0xf bank_mask:0xf
    v_and_b32_dpp v18, v39, v6 row_newbcast:10 row_mask:0xf bank_mask:0xf
    v_and_b32_dpp v19, v39, v7 row_newbcast:10 row_mask:0xf bank_mask:0xf
    s_waitcnt vmcnt(5)
    s_cmp_ge_u32 s93, 16
    s_cbranch_scc1 L_d190
    s_waitcnt vmcnt(4)
L_d190:
    buffer_load_dwordx4 v[152:155], v2, s[40:43], s45 offen offset:2048 nt
    s_mov_b32 s32, 862208
    buffer_load_dword v54, v48, s[48:51], s32 offen nt
    v_mfma_f32_16x16x32_bf16 v[32:35], v[8:11], v[128:131], v[32:35]
    v_and_b32_dpp v20, v39, v4 row_newbcast:14 row_mask:0xf bank_mask:0xf
    v_and_b32_dpp v21, v39, v5 row_newbcast:14 row_mask:0xf bank_mask:0xf
    v_and_b32_dpp v22, v39, v6 row_newbcast:14 row_mask:0xf bank_mask:0xf
    v_and_b32_dpp v23, v39, v7 row_newbcast:14 row_mask:0xf bank_mask:0xf
    s_waitcnt vmcnt(6)
    s_cmp_ge_u32 s93, 16
    s_cbranch_scc1 L_d191
    s_waitcnt vmcnt(5)
L_d191:
    buffer_load_dwordx4 v[156:159], v2, s[40:43], s45 offen offset:3072 nt
    s_add_u32 s45, s45, 49152
    s_waitcnt vmcnt(6)
    s_cmp_ge_u32 s93, 16
    s_cbranch_scc1 L_d192
    s_waitcnt vmcnt(5)
L_d192:
    buffer_load_dwordx4 v[160:163], v2, s[40:43], s45 offen offset:0 nt
    s_mov_b32 s32, 862208
    buffer_store_dword v60, v49, s[48:51], s32 offen
    v_mfma_f32_16x16x32_bf16 v[32:35], v[12:15], v[132:135], v[32:35]
    v_and_b32_dpp v8, v39, v4 row_newbcast:3 row_mask:0xf bank_mask:0xf
    v_and_b32_dpp v9, v39, v5 row_newbcast:3 row_mask:0xf bank_mask:0xf
    v_and_b32_dpp v10, v39, v6 row_newbcast:3 row_mask:0xf bank_mask:0xf
    v_and_b32_dpp v11, v39, v7 row_newbcast:3 row_mask:0xf bank_mask:0xf
    s_waitcnt vmcnt(7)
    s_cmp_ge_u32 s93, 16
    s_cbranch_scc1 L_d193
    s_waitcnt vmcnt(6)
L_d193:
    buffer_load_dwordx4 v[164:167], v2, s[40:43], s45 offen offset:1024 nt
    s_waitcnt vmcnt(7)
    s_cmp_ge_u32 s93, 16
    s_cbranch_scc1 L_d194
    s_waitcnt vmcnt(6)
L_d194:
    buffer_load_dwordx4 v[168:171], v2, s[40:43], s45 offen offset:2048 nt
    v_mfma_f32_16x16x32_bf16 v[32:35], v[16:19], v[136:139], v[32:35]
    v_and_b32_dpp v12, v39, v4 row_newbcast:7 row_mask:0xf bank_mask:0xf
    v_and_b32_dpp v13, v39, v5 row_newbcast:7 row_mask:0xf bank_mask:0xf
    v_and_b32_dpp v14, v39, v6 row_newbcast:7 row_mask:0xf bank_mask:0xf
    v_and_b32_dpp v15, v39, v7 row_newbcast:7 row_mask:0xf bank_mask:0xf
    s_waitcnt vmcnt(7)
    s_cmp_ge_u32 s93, 16
    s_cbranch_scc1 L_d195
    s_waitcnt vmcnt(6)
    s_cmp_lt_i32 s95, -3
    s_cbranch_scc0 L_d195
    s_waitcnt vmcnt(4)
L_d195:
    buffer_load_dwordx4 v[172:175], v2, s[40:43], s45 offen offset:3072 nt
    s_add_u32 s45, s45, 16384
    v_mfma_f32_16x16x32_bf16 v[32:35], v[20:23], v[140:143], v[32:35]
    v_and_b32_dpp v16, v39, v4 row_newbcast:11 row_mask:0xf bank_mask:0xf
    v_and_b32_dpp v17, v39, v5 row_newbcast:11 row_mask:0xf bank_mask:0xf
    v_and_b32_dpp v18, v39, v6 row_newbcast:11 row_mask:0xf bank_mask:0xf
    v_and_b32_dpp v19, v39, v7 row_newbcast:11 row_mask:0xf bank_mask:0xf
    s_waitcnt vmcnt(7)
    s_cmp_ge_u32 s93, 16
    s_cbranch_scc1 L_d196
    s_waitcnt vmcnt(5)
L_d196:
    buffer_load_dwordx4 v[176:179], v2, s[40:43], s45 offen offset:0 nt
    v_mfma_f32_16x16x32_bf16 v[32:35], v[8:11], v[144:147], v[32:35]
    v_and_b32_dpp v20, v39, v4 row_newbcast:15 row_mask:0xf bank_mask:0xf
    v_and_b32_dpp v21, v39, v5 row_newbcast:15 row_mask:0xf bank_mask:0xf
    v_and_b32_dpp v22, v39, v6 row_newbcast:15 row_mask:0xf bank_mask:0xf
    v_and_b32_dpp v23, v39, v7 row_newbcast:15 row_mask:0xf bank_mask:0xf
    s_waitcnt vmcnt(6)
    s_cmp_ge_u32 s93, 16
    s_cbranch_scc1 L_d197
    s_waitcnt vmcnt(5)
L_d197:
    buffer_load_dwordx4 v[180:183], v2, s[40:43], s45 offen offset:1024 nt
    v_mfma_f32_16x16x32_bf16 v[32:35], v[12:15], v[148:151], v[32:35]
    v_and_b32_dpp v8, v40, v4 row_newbcast:0 row_mask:0xf bank_mask:0xf
    v_and_b32_dpp v9, v40, v5 row_newbcast:0 row_mask:0xf bank_mask:0xf
    v_and_b32_dpp v10, v40, v6 row_newbcast:0 row_mask:0xf bank_mask:0xf
    v_and_b32_dpp v11, v40, v7 row_newbcast:0 row_mask:0xf bank_mask:0xf
    v_mfma_f32_16x16x32_bf16 v[32:35], v[16:19], v[152:155], v[32:35]
    v_and_b32_dpp v12, v40, v4 row_newbcast:4 row_mask:0xf bank_mask:0xf
    v_and_b32_dpp v13, v40, v5 row_newbcast:4 row_mask:0xf bank_mask:0xf
    v_and_b32_dpp v14, v40, v6 row_newbcast:4 row_mask:0xf bank_mask:0xf
    v_and_b32_dpp v15, v40, v7 row_newbcast:4 row_mask:0xf bank_mask:0xf
    s_waitcnt vmcnt(6)
    s_cmp_ge_u32 s93, 16
    s_cbranch_scc1 L_d198
    s_waitcnt vmcnt(4)
L_d198:
    buffer_load_dwordx4 v[184:187], v2, s[40:43], s45 offen offset:2048 nt
    v_mfma_f32_16x16x32_bf16 v[32:35], v[20:23], v[156:159], v[32:35]
    v_and_b32_dpp v16, v40, v4 row_newbcast:8 row_mask:0xf bank_mask:0xf
    v_and_b32_dpp v17, v40, v5 row_newbcast:8 row_mask:0xf bank_mask:0xf
    v_and_b32_dpp v18, v40, v6 row_newbcast:8 row_mask:0xf bank_mask:0xf
    v_and_b32_dpp v19, v40, v7 row_newbcast:8 row_mask:0xf bank_mask:0xf
    s_waitcnt vmcnt(5)
    s_cmp_ge_u32 s93, 16
    s_cbranch_scc1 L_d199
    s_waitcnt vmcnt(4)
L_d199:
    buffer_load_dwordx4 v[188:191], v2, s[40:43], s45 offen offset:3072 nt
    s_add_u32 s45, s45, 49152
    v_cmp_eq_u32 vcc, v60, v54
    s_nop 0
    s_bcnt1_i32_b64 s93, vcc
    v_mfma_f32_16x16x32_bf16 v[32:35], v[8:11], v[160:163], v[32:35]
    v_and_b32_dpp v20, v40, v4 row_newbcast:12 row_mask:0xf bank_mask:0xf
    v_and_b32_dpp v21, v40, v5 row_newbcast:12 row_mask:0xf bank_mask:0xf
    v_and_b32_dpp v22, v40, v6 row_newbcast:12 row_mask:0xf bank_mask:0xf
    v_and_b32_dpp v23, v40, v7 row_newbcast:12 row_mask:0xf bank_mask:0xf
    v_mfma_f32_16x16x32_bf16 v[32:35], v[12:15], v[164:167], v[32:35]
    v_and_b32_dpp v8, v40, v4 row_newbcast:1 row_mask:0xf bank_mask:0xf
    v_and_b32_dpp v9, v40, v5 row_newbcast:1 row_mask:0xf bank_mask:0xf
    v_and_b32_dpp v10, v40, v6 row_newbcast:1 row_mask:0xf bank_mask:0xf
    v_and_b32_dpp v11, v40, v7 row_newbcast:1 row_mask:0xf bank_mask:0xf
    s_waitcnt vmcnt(5)
    s_cmp_ge_u32 s93, 16
    s_cbranch_scc1 L_d200
    s_waitcnt vmcnt(4)
L_d200:
    buffer_load_dwordx4 v[192:195], v2, s[40:43], s45 offen offset:0 nt
    v_mfma_f32_16x16x32_bf16 v[32:35], v[16:19], v[168:171], v[32:35]
    v_and_b32_dpp v12, v40, v4 row_newbcast:5 row_mask:0xf bank_mask:0xf
    v_and_b32_dpp v13, v40, v5 row_newbcast:5 row_mask:0xf bank_mask:0xf
    v_and_b32_dpp v14, v40, v6 row_newbcast:5 row_mask:0xf bank_mask:0xf
    v_and_b32_dpp v15, v40, v7 row_newbcast:5 row_mask:0xf bank_mask:0xf
    s_waitcnt vmcnt(5)
    s_cmp_ge_u32 s93, 16
    s_cbranch_scc1 L_d201
    s_waitcnt vmcnt(4)
L_d201:
    buffer_load_dwordx4 v[196:199], v2, s[40:43], s45 offen offset:1024 nt
    v_mfma_f32_16x16x32_bf16 v[32:35], v[20:23], v[172:175], v[32:35]
    v_and_b32_dpp v16, v40, v4 row_newbcast:9 row_mask:0xf bank_mask:0xf
    v_and_b32_dpp v17, v40, v5 row_newbcast:9 row_mask:0xf bank_mask:0xf
    v_and_b32_dpp v18, v40, v6 row_newbcast:9 row_mask:0xf bank_mask:0xf
    v_and_b32_dpp v19, v40, v7 row_newbcast:9 row_mask:0xf bank_mask:0xf
    s_waitcnt vmcnt(5)
    s_cmp_ge_u32 s93, 16
    s_cbranch_scc1 L_d202
    s_waitcnt vmcnt(4)
L_d202:
    buffer_load_dwordx4 v[200:203], v2, s[40:43], s45 offen offset:2048 nt
    v_mfma_f32_16x16x32_bf16 v[32:35], v[8:11], v[176:179], v[32:35]
    v_and_b32_dpp v20, v40, v4 row_newbcast:13 row_mask:0xf bank_mask:0xf
    v_and_b32_dpp v21, v40, v5 row_newbcast:13 row_mask:0xf bank_mask:0xf
    v_and_b32_dpp v22, v40, v6 row_newbcast:13 row_mask:0xf bank_mask:0xf
    v_and_b32_dpp v23, v40, v7 row_newbcast:13 row_mask:0xf bank_mask:0xf
    s_waitcnt vmcnt(5)
    s_cmp_ge_u32 s93, 16
    s_cbranch_scc1 L_d203
    s_waitcnt vmcnt(4)
L_d203:
    buffer_load_dwordx4 v[204:207], v2, s[40:43], s45 offen offset:3072 nt
    s_add_u32 s45, s45, 16384
    v_mfma_f32_16x16x32_bf16 v[32:35], v[12:15], v[180:183], v[32:35]
    v_and_b32_dpp v8, v40, v4 row_newbcast:2 row_mask:0xf bank_mask:0xf
    v_and_b32_dpp v9, v40, v5 row_newbcast:2 row_mask:0xf bank_mask:0xf
    v_and_b32_dpp v10, v40, v6 row_newbcast:2 row_mask:0xf bank_mask:0xf
    v_and_b32_dpp v11, v40, v7 row_newbcast:2 row_mask:0xf bank_mask:0xf
    s_waitcnt vmcnt(5)
    s_cmp_ge_u32 s93, 16
    s_cbranch_scc1 L_d204
    s_waitcnt vmcnt(4)
L_d204:
    buffer_load_dwordx4 v[208:211], v2, s[40:43], s45 offen offset:0 nt
    v_mfma_f32_16x16x32_bf16 v[32:35], v[16:19], v[184:187], v[32:35]
    v_and_b32_dpp v12, v40, v4 row_newbcast:6 row_mask:0xf bank_mask:0xf
    v_and_b32_dpp v13, v40, v5 row_newbcast:6 row_mask:0xf bank_mask:0xf
    v_and_b32_dpp v14, v40, v6 row_newbcast:6 row_mask:0xf bank_mask:0xf
    v_and_b32_dpp v15, v40, v7 row_newbcast:6 row_mask:0xf bank_mask:0xf
    s_waitcnt vmcnt(5)
    s_cmp_ge_u32 s93, 16
    s_cbranch_scc1 L_d205
    s_waitcnt vmcnt(4)
L_d205:
    buffer_load_dwordx4 v[212:215], v2, s[40:43], s45 offen offset:1024 nt
    v_mfma_f32_16x16x32_bf16 v[32:35], v[20:23], v[188:191], v[32:35]
    v_and_b32_dpp v16, v40, v4 row_newbcast:10 row_mask:0xf bank_mask:0xf
    v_and_b32_dpp v17, v40, v5 row_newbcast:10 row_mask:0xf bank_mask:0xf
    v_and_b32_dpp v18, v40, v6 row_newbcast:10 row_mask:0xf bank_mask:0xf
    v_and_b32_dpp v19, v40, v7 row_newbcast:10 row_mask:0xf bank_mask:0xf
    s_waitcnt vmcnt(5)
    s_cmp_ge_u32 s93, 16
    s_cbranch_scc1 L_d206
    s_waitcnt vmcnt(4)
L_d206:
    buffer_load_dwordx4 v[216:219], v2, s[40:43], s45 offen offset:2048 nt
    s_mov_b32 s32, 863232
    buffer_load_dword v47, v48, s[48:51], s32 offen nt
    v_mfma_f32_16x16x32_bf16 v[32:35], v[8:11], v[192:195], v[32:35]
    s_mov_b64 exec, 1
    ds_write_b32 v63, v63 offset:3392
    s_mov_b64 exec, -1
    v_and_b32_dpp v20, v40, v4 row_newbcast:14 row_mask:0xf bank_mask:0xf
    v_and_b32_dpp v21, v40, v5 row_newbcast:14 row_mask:0xf bank_mask:0xf
    v_and_b32_dpp v22, v40, v6 row_newbcast:14 row_mask:0xf bank_mask:0xf
    v_and_b32_dpp v23, v40, v7 row_newbcast:14 row_mask:0xf bank_mask:0xf
    s_waitcnt vmcnt(6)
    s_cmp_ge_u32 s93, 16
    s_cbranch_scc1 L_d207
    s_waitcnt vmcnt(5)
L_d207:
    buffer_load_dwordx4 v[220:223], v2, s[40:43], s45 offen offset:3072 nt
    s_add_u32 s45, s45, 49152
    s_waitcnt vmcnt(6)
    s_cmp_ge_u32 s93, 16
    s_cbranch_scc1 L_d208
    s_waitcnt vmcnt(5)
L_d208:
    buffer_load_dwordx4 v[224:227], v2, s[40:43], s45 offen offset:0 nt
    s_mov_b32 s32, 863232
    buffer_store_dword v60, v49, s[48:51], s32 offen
    v_mfma_f32_16x16x32_bf16 v[32:35], v[12:15], v[196:199], v[32:35]
    v_and_b32_dpp v8, v40, v4 row_newbcast:3 row_mask:0xf bank_mask:0xf
    v_and_b32_dpp v9, v40, v5 row_newbcast:3 row_mask:0xf bank_mask:0xf
    v_and_b32_dpp v10, v40, v6 row_newbcast:3 row_mask:0xf bank_mask:0xf
    v_and_b32_dpp v11, v40, v7 row_newbcast:3 row_mask:0xf bank_mask:0xf
    s_waitcnt vmcnt(7)
    s_cmp_ge_u32 s93, 16
    s_cbranch_scc1 L_d209
    s_waitcnt vmcnt(6)
L_d209:
    buffer_load_dwordx4 v[228:231], v2, s[40:43], s45 offen offset:1024 nt
    s_waitcnt vmcnt(7)
    s_cmp_ge_u32 s93, 16
    s_cbranch_scc1 L_d210
    s_waitcnt vmcnt(6)
L_d210:
    buffer_load_dwordx4 v[232:235], v2, s[40:43], s45 offen offset:2048 nt
    v_mfma_f32_16x16x32_bf16 v[32:35], v[16:19], v[200:203], v[32:35]
    v_and_b32_dpp v12, v40, v4 row_newbcast:7 row_mask:0xf bank_mask:0xf
    v_and_b32_dpp v13, v40, v5 row_newbcast:7 row_mask:0xf bank_mask:0xf
    v_and_b32_dpp v14, v40, v6 row_newbcast:7 row_mask:0xf bank_mask:0xf
    v_and_b32_dpp v15, v40, v7 row_newbcast:7 row_mask:0xf bank_mask:0xf
    s_waitcnt vmcnt(7)
    s_cmp_ge_u32 s93, 16
    s_cbranch_scc1 L_d211
    s_waitcnt vmcnt(6)
    s_cmp_lt_i32 s95, -11
    s_cbranch_scc0 L_d211
    s_waitcnt vmcnt(4)
L_d211:
    buffer_load_dwordx4 v[236:239], v2, s[40:43], s45 offen offset:3072 nt
    s_add_u32 s45, s45, 16384
    v_mfma_f32_16x16x32_bf16 v[32:35], v[20:23], v[204:207], v[32:35]
    v_and_b32_dpp v16, v40, v4 row_newbcast:11 row_mask:0xf bank_mask:0xf
    v_and_b32_dpp v17, v40, v5 row_newbcast:11 row_mask:0xf bank_mask:0xf
    v_and_b32_dpp v18, v40, v6 row_newbcast:11 row_mask:0xf bank_mask:0xf
    v_and_b32_dpp v19, v40, v7 row_newbcast:11 row_mask:0xf bank_mask:0xf
    s_waitcnt vmcnt(7)
    s_cmp_ge_u32 s93, 16
    s_cbranch_scc1 L_d212
    s_waitcnt vmcnt(5)
L_d212:
    buffer_load_dwordx4 v[240:243], v2, s[40:43], s45 offen offset:0 nt
    v_mfma_f32_16x16x32_bf16 v[32:35], v[8:11], v[208:211], v[32:35]
    v_and_b32_dpp v20, v40, v4 row_newbcast:15 row_mask:0xf bank_mask:0xf
    v_and_b32_dpp v21, v40, v5 row_newbcast:15 row_mask:0xf bank_mask:0xf
    v_and_b32_dpp v22, v40, v6 row_newbcast:15 row_mask:0xf bank_mask:0xf
    v_and_b32_dpp v23, v40, v7 row_newbcast:15 row_mask:0xf bank_mask:0xf
    s_waitcnt vmcnt(6)
    s_cmp_ge_u32 s93, 16
    s_cbranch_scc1 L_d213
    s_waitcnt vmcnt(5)
L_d213:
    buffer_load_dwordx4 v[244:247], v2, s[40:43], s45 offen offset:1024 nt
    v_mfma_f32_16x16x32_bf16 v[32:35], v[12:15], v[212:215], v[32:35]
    v_and_b32_dpp v8, v41, v4 row_newbcast:0 row_mask:0xf bank_mask:0xf
    v_and_b32_dpp v9, v41, v5 row_newbcast:0 row_mask:0xf bank_mask:0xf
    v_and_b32_dpp v10, v41, v6 row_newbcast:0 row_mask:0xf bank_mask:0xf
    v_and_b32_dpp v11, v41, v7 row_newbcast:0 row_mask:0xf bank_mask:0xf
    v_mfma_f32_16x16x32_bf16 v[32:35], v[16:19], v[216:219], v[32:35]
    v_and_b32_dpp v12, v41, v4 row_newbcast:4 row_mask:0xf bank_mask:0xf
    v_and_b32_dpp v13, v41, v5 row_newbcast:4 row_mask:0xf bank_mask:0xf
    v_and_b32_dpp v14, v41, v6 row_newbcast:4 row_mask:0xf bank_mask:0xf
    v_and_b32_dpp v15, v41, v7 row_newbcast:4 row_mask:0xf bank_mask:0xf
    s_waitcnt vmcnt(6)
    s_cmp_ge_u32 s93, 16
    s_cbranch_scc1 L_d214
    s_waitcnt vmcnt(4)
L_d214:
    buffer_load_dwordx4 v[248:251], v2, s[40:43], s45 offen offset:2048 nt
    v_mfma_f32_16x16x32_bf16 v[32:35], v[20:23], v[220:223], v[32:35]
    v_and_b32_dpp v16, v41, v4 row_newbcast:8 row_mask:0xf bank_mask:0xf
    v_and_b32_dpp v17, v41, v5 row_newbcast:8 row_mask:0xf bank_mask:0xf
    v_and_b32_dpp v18, v41, v6 row_newbcast:8 row_mask:0xf bank_mask:0xf
    v_and_b32_dpp v19, v41, v7 row_newbcast:8 row_mask:0xf bank_mask:0xf
    s_waitcnt vmcnt(5)
    s_cmp_ge_u32 s93, 16
    s_cbranch_scc1 L_d215
    s_waitcnt vmcnt(4)
L_d215:
    buffer_load_dwordx4 v[252:255], v2, s[40:43], s45 offen offset:3072 nt
    s_add_u32 s45, s45, 49152
    v_cmp_eq_u32 vcc, v60, v47
    s_nop 0
    s_bcnt1_i32_b64 s93, vcc
    v_mfma_f32_16x16x32_bf16 v[32:35], v[8:11], v[224:227], v[32:35]
    v_and_b32_dpp v20, v41, v4 row_newbcast:12 row_mask:0xf bank_mask:0xf
    v_and_b32_dpp v21, v41, v5 row_newbcast:12 row_mask:0xf bank_mask:0xf
    v_and_b32_dpp v22, v41, v6 row_newbcast:12 row_mask:0xf bank_mask:0xf
    v_and_b32_dpp v23, v41, v7 row_newbcast:12 row_mask:0xf bank_mask:0xf
    v_mfma_f32_16x16x32_bf16 v[32:35], v[12:15], v[228:231], v[32:35]
    v_and_b32_dpp v8, v41, v4 row_newbcast:1 row_mask:0xf bank_mask:0xf
    v_and_b32_dpp v9, v41, v5 row_newbcast:1 row_mask:0xf bank_mask:0xf
    v_and_b32_dpp v10, v41, v6 row_newbcast:1 row_mask:0xf bank_mask:0xf
    v_and_b32_dpp v11, v41, v7 row_newbcast:1 row_mask:0xf bank_mask:0xf
    s_waitcnt vmcnt(5)
    s_cmp_ge_u32 s93, 16
    s_cbranch_scc1 L_d216
    s_waitcnt vmcnt(4)
L_d216:
    buffer_load_dwordx4 v[64:67], v2, s[40:43], s45 offen offset:0 nt
    v_mfma_f32_16x16x32_bf16 v[32:35], v[16:19], v[232:235], v[32:35]
    v_and_b32_dpp v12, v41, v4 row_newbcast:5 row_mask:0xf bank_mask:0xf
    v_and_b32_dpp v13, v41, v5 row_newbcast:5 row_mask:0xf bank_mask:0xf
    v_and_b32_dpp v14, v41, v6 row_newbcast:5 row_mask:0xf bank_mask:0xf
    v_and_b32_dpp v15, v41, v7 row_newbcast:5 row_mask:0xf bank_mask:0xf
    s_waitcnt vmcnt(5)
    s_cmp_ge_u32 s93, 16
    s_cbranch_scc1 L_d217
    s_waitcnt vmcnt(4)
L_d217:
    buffer_load_dwordx4 v[68:71], v2, s[40:43], s45 offen offset:1024 nt
    v_mfma_f32_16x16x32_bf16 v[32:35], v[20:23], v[236:239], v[32:35]
    v_and_b32_dpp v16, v41, v4 row_newbcast:9 row_mask:0xf bank_mask:0xf
    v_and_b32_dpp v17, v41, v5 row_newbcast:9 row_mask:0xf bank_mask:0xf
    v_and_b32_dpp v18, v41, v6 row_newbcast:9 row_mask:0xf bank_mask:0xf
    v_and_b32_dpp v19, v41, v7 row_newbcast:9 row_mask:0xf bank_mask:0xf
    s_waitcnt vmcnt(5)
    s_cmp_ge_u32 s93, 16
    s_cbranch_scc1 L_d218
    s_waitcnt vmcnt(4)
L_d218:
    buffer_load_dwordx4 v[72:75], v2, s[40:43], s45 offen offset:2048 nt
    v_mfma_f32_16x16x32_bf16 v[32:35], v[8:11], v[240:243], v[32:35]
    v_and_b32_dpp v20, v41, v4 row_newbcast:13 row_mask:0xf bank_mask:0xf
    v_and_b32_dpp v21, v41, v5 row_newbcast:13 row_mask:0xf bank_mask:0xf
    v_and_b32_dpp v22, v41, v6 row_newbcast:13 row_mask:0xf bank_mask:0xf
    v_and_b32_dpp v23, v41, v7 row_newbcast:13 row_mask:0xf bank_mask:0xf
    s_waitcnt vmcnt(5)
    s_cmp_ge_u32 s93, 16
    s_cbranch_scc1 L_d219
    s_waitcnt vmcnt(4)
L_d219:
    buffer_load_dwordx4 v[76:79], v2, s[40:43], s45 offen offset:3072 nt
    s_add_u32 s45, s45, 16384
    v_mfma_f32_16x16x32_bf16 v[32:35], v[12:15], v[244:247], v[32:35]
    v_and_b32_dpp v8, v41, v4 row_newbcast:2 row_mask:0xf bank_mask:0xf
    v_and_b32_dpp v9, v41, v5 row_newbcast:2 row_mask:0xf bank_mask:0xf
    v_and_b32_dpp v10, v41, v6 row_newbcast:2 row_mask:0xf bank_mask:0xf
    v_and_b32_dpp v11, v41, v7 row_newbcast:2 row_mask:0xf bank_mask:0xf
    s_waitcnt vmcnt(5)
    s_cmp_ge_u32 s93, 16
    s_cbranch_scc1 L_d220
    s_waitcnt vmcnt(4)
L_d220:
    buffer_load_dwordx4 v[80:83], v2, s[40:43], s45 offen offset:0 nt
    v_mfma_f32_16x16x32_bf16 v[32:35], v[16:19], v[248:251], v[32:35]
    v_and_b32_dpp v12, v41, v4 row_newbcast:6 row_mask:0xf bank_mask:0xf
    v_and_b32_dpp v13, v41, v5 row_newbcast:6 row_mask:0xf bank_mask:0xf
    v_and_b32_dpp v14, v41, v6 row_newbcast:6 row_mask:0xf bank_mask:0xf
    v_and_b32_dpp v15, v41, v7 row_newbcast:6 row_mask:0xf bank_mask:0xf
    s_waitcnt vmcnt(5)
    s_cmp_ge_u32 s93, 16
    s_cbranch_scc1 L_d221
    s_waitcnt vmcnt(4)
L_d221:
    buffer_load_dwordx4 v[84:87], v2, s[40:43], s45 offen offset:1024 nt
    v_mfma_f32_16x16x32_bf16 v[32:35], v[20:23], v[252:255], v[32:35]
    v_and_b32_dpp v16, v41, v4 row_newbcast:10 row_mask:0xf bank_mask:0xf
    v_and_b32_dpp v17, v41, v5 row_newbcast:10 row_mask:0xf bank_mask:0xf
    v_and_b32_dpp v18, v41, v6 row_newbcast:10 row_mask:0xf bank_mask:0xf
    v_and_b32_dpp v19, v41, v7 row_newbcast:10 row_mask:0xf bank_mask:0xf
    s_waitcnt vmcnt(5)
    s_cmp_ge_u32 s93, 16
    s_cbranch_scc1 L_d222
    s_waitcnt vmcnt(4)
L_d222:
    buffer_load_dwordx4 v[88:91], v2, s[40:43], s45 offen offset:2048 nt
    s_mov_b32 s32, 864256
    buffer_load_dword v54, v48, s[48:51], s32 offen nt
    v_mfma_f32_16x16x32_bf16 v[32:35], v[8:11], v[64:67], v[32:35]
    v_and_b32_dpp v20, v41, v4 row_newbcast:14 row_mask:0xf bank_mask:0xf
    v_and_b32_dpp v21, v41, v5 row_newbcast:14 row_mask:0xf bank_mask:0xf
    v_and_b32_dpp v22, v41, v6 row_newbcast:14 row_mask:0xf bank_mask:0xf
    v_and_b32_dpp v23, v41, v7 row_newbcast:14 row_mask:0xf bank_mask:0xf
    s_waitcnt vmcnt(6)
    s_cmp_ge_u32 s93, 16
    s_cbranch_scc1 L_d223
    s_waitcnt vmcnt(5)
L_d223:
    buffer_load_dwordx4 v[92:95], v2, s[40:43], s45 offen offset:3072 nt
    s_add_u32 s45, s45, 49152
    s_waitcnt vmcnt(6)
    s_cmp_ge_u32 s93, 16
    s_cbranch_scc1 L_d224
    s_waitcnt vmcnt(5)
L_d224:
    buffer_load_dwordx4 v[96:99], v2, s[40:43], s45 offen offset:0 nt
    s_mov_b32 s32, 864256
    buffer_store_dword v60, v49, s[48:51], s32 offen
    v_mfma_f32_16x16x32_bf16 v[32:35], v[12:15], v[68:71], v[32:35]
    v_and_b32_dpp v8, v41, v4 row_newbcast:3 row_mask:0xf bank_mask:0xf
    v_and_b32_dpp v9, v41, v5 row_newbcast:3 row_mask:0xf bank_mask:0xf
    v_and_b32_dpp v10, v41, v6 row_newbcast:3 row_mask:0xf bank_mask:0xf
    v_and_b32_dpp v11, v41, v7 row_newbcast:3 row_mask:0xf bank_mask:0xf
    s_waitcnt vmcnt(7)
    s_cmp_ge_u32 s93, 16
    s_cbranch_scc1 L_d225
    s_waitcnt vmcnt(6)
L_d225:
    buffer_load_dwordx4 v[100:103], v2, s[40:43], s45 offen offset:1024 nt
    s_waitcnt vmcnt(7)
    s_cmp_ge_u32 s93, 16
    s_cbranch_scc1 L_d226
    s_waitcnt vmcnt(6)
L_d226:
    buffer_load_dwordx4 v[104:107], v2, s[40:43], s45 offen offset:2048 nt
    v_mfma_f32_16x16x32_bf16 v[32:35], v[16:19], v[72:75], v[32:35]
    v_and_b32_dpp v12, v41, v4 row_newbcast:7 row_mask:0xf bank_mask:0xf
    v_and_b32_dpp v13, v41, v5 row_newbcast:7 row_mask:0xf bank_mask:0xf
    v_and_b32_dpp v14, v41, v6 row_newbcast:7 row_mask:0xf bank_mask:0xf
    v_and_b32_dpp v15, v41, v7 row_newbcast:7 row_mask:0xf bank_mask:0xf
    s_waitcnt vmcnt(7)
    s_cmp_ge_u32 s93, 16
    s_cbranch_scc1 L_d227
    s_waitcnt vmcnt(6)
    s_cmp_lt_i32 s95, -7
    s_cbranch_scc0 L_d227
    s_waitcnt vmcnt(4)
L_d227:
    buffer_load_dwordx4 v[108:111], v2, s[40:43], s45 offen offset:3072 nt
    s_add_u32 s45, s45, 16384
    v_mfma_f32_16x16x32_bf16 v[32:35], v[20:23], v[76:79], v[32:35]
    v_and_b32_dpp v16, v41, v4 row_newbcast:11 row_mask:0xf bank_mask:0xf
    v_and_b32_dpp v17, v41, v5 row_newbcast:11 row_mask:0xf bank_mask:0xf
    v_and_b32_dpp v18, v41, v6 row_newbcast:11 row_mask:0xf bank_mask:0xf
    v_and_b32_dpp v19, v41, v7 row_newbcast:11 row_mask:0xf bank_mask:0xf
    s_waitcnt vmcnt(7)
    s_cmp_ge_u32 s93, 16
    s_cbranch_scc1 L_d228
    s_waitcnt vmcnt(5)
L_d228:
    buffer_load_dwordx4 v[112:115], v2, s[40:43], s45 offen offset:0 nt
    v_mfma_f32_16x16x32_bf16 v[32:35], v[8:11], v[80:83], v[32:35]
    v_and_b32_dpp v20, v41, v4 row_newbcast:15 row_mask:0xf bank_mask:0xf
    v_and_b32_dpp v21, v41, v5 row_newbcast:15 row_mask:0xf bank_mask:0xf
    v_and_b32_dpp v22, v41, v6 row_newbcast:15 row_mask:0xf bank_mask:0xf
    v_and_b32_dpp v23, v41, v7 row_newbcast:15 row_mask:0xf bank_mask:0xf
    s_waitcnt vmcnt(6)
    s_cmp_ge_u32 s93, 16
    s_cbranch_scc1 L_d229
    s_waitcnt vmcnt(5)
L_d229:
    buffer_load_dwordx4 v[116:119], v2, s[40:43], s45 offen offset:1024 nt
    v_mfma_f32_16x16x32_bf16 v[32:35], v[12:15], v[84:87], v[32:35]
    v_and_b32_dpp v8, v42, v4 row_newbcast:0 row_mask:0xf bank_mask:0xf
    v_and_b32_dpp v9, v42, v5 row_newbcast:0 row_mask:0xf bank_mask:0xf
    v_and_b32_dpp v10, v42, v6 row_newbcast:0 row_mask:0xf bank_mask:0xf
    v_and_b32_dpp v11, v42, v7 row_newbcast:0 row_mask:0xf bank_mask:0xf
    v_mfma_f32_16x16x32_bf16 v[32:35], v[16:19], v[88:91], v[32:35]
    v_and_b32_dpp v12, v42, v4 row_newbcast:4 row_mask:0xf bank_mask:0xf
    v_and_b32_dpp v13, v42, v5 row_newbcast:4 row_mask:0xf bank_mask:0xf
    v_and_b32_dpp v14, v42, v6 row_newbcast:4 row_mask:0xf bank_mask:0xf
    v_and_b32_dpp v15, v42, v7 row_newbcast:4 row_mask:0xf bank_mask:0xf
    s_waitcnt vmcnt(6)
    s_cmp_ge_u32 s93, 16
    s_cbranch_scc1 L_d230
    s_waitcnt vmcnt(4)
L_d230:
    buffer_load_dwordx4 v[120:123], v2, s[40:43], s45 offen offset:2048 nt
    v_mfma_f32_16x16x32_bf16 v[32:35], v[20:23], v[92:95], v[32:35]
    v_and_b32_dpp v16, v42, v4 row_newbcast:8 row_mask:0xf bank_mask:0xf
    v_and_b32_dpp v17, v42, v5 row_newbcast:8 row_mask:0xf bank_mask:0xf
    v_and_b32_dpp v18, v42, v6 row_newbcast:8 row_mask:0xf bank_mask:0xf
    v_and_b32_dpp v19, v42, v7 row_newbcast:8 row_mask:0xf bank_mask:0xf
    s_waitcnt vmcnt(5)
    s_cmp_ge_u32 s93, 16
    s_cbranch_scc1 L_d231
    s_waitcnt vmcnt(4)
L_d231:
    buffer_load_dwordx4 v[124:127], v2, s[40:43], s45 offen offset:3072 nt
    s_add_u32 s45, s45, 49152
    v_cmp_eq_u32 vcc, v60, v54
    s_nop 0
    s_bcnt1_i32_b64 s93, vcc
    v_mfma_f32_16x16x32_bf16 v[32:35], v[8:11], v[96:99], v[32:35]
    v_and_b32_dpp v20, v42, v4 row_newbcast:12 row_mask:0xf bank_mask:0xf
    v_and_b32_dpp v21, v42, v5 row_newbcast:12 row_mask:0xf bank_mask:0xf
    v_and_b32_dpp v22, v42, v6 row_newbcast:12 row_mask:0xf bank_mask:0xf
    v_and_b32_dpp v23, v42, v7 row_newbcast:12 row_mask:0xf bank_mask:0xf
    v_mfma_f32_16x16x32_bf16 v[32:35], v[12:15], v[100:103], v[32:35]
    v_and_b32_dpp v8, v42, v4 row_newbcast:1 row_mask:0xf bank_mask:0xf
    v_and_b32_dpp v9, v42, v5 row_newbcast:1 row_mask:0xf bank_mask:0xf
    v_and_b32_dpp v10, v42, v6 row_newbcast:1 row_mask:0xf bank_mask:0xf
    v_and_b32_dpp v11, v42, v7 row_newbcast:1 row_mask:0xf bank_mask:0xf
    s_waitcnt vmcnt(5)
    s_cmp_ge_u32 s93, 16
    s_cbranch_scc1 L_d232
    s_waitcnt vmcnt(4)
L_d232:
    buffer_load_dwordx4 v[128:131], v2, s[40:43], s45 offen offset:0 nt
    v_mfma_f32_16x16x32_bf16 v[32:35], v[16:19], v[104:107], v[32:35]
    v_and_b32_dpp v12, v42, v4 row_newbcast:5 row_mask:0xf bank_mask:0xf
    v_and_b32_dpp v13, v42, v5 row_newbcast:5 row_mask:0xf bank_mask:0xf
    v_and_b32_dpp v14, v42, v6 row_newbcast:5 row_mask:0xf bank_mask:0xf
    v_and_b32_dpp v15, v42, v7 row_newbcast:5 row_mask:0xf bank_mask:0xf
    s_waitcnt vmcnt(5)
    s_cmp_ge_u32 s93, 16
    s_cbranch_scc1 L_d233
    s_waitcnt vmcnt(4)
L_d233:
    buffer_load_dwordx4 v[132:135], v2, s[40:43], s45 offen offset:1024 nt
    v_mfma_f32_16x16x32_bf16 v[32:35], v[20:23], v[108:111], v[32:35]
    v_and_b32_dpp v16, v42, v4 row_newbcast:9 row_mask:0xf bank_mask:0xf
    v_and_b32_dpp v17, v42, v5 row_newbcast:9 row_mask:0xf bank_mask:0xf
    v_and_b32_dpp v18, v42, v6 row_newbcast:9 row_mask:0xf bank_mask:0xf
    v_and_b32_dpp v19, v42, v7 row_newbcast:9 row_mask:0xf bank_mask:0xf
    s_waitcnt vmcnt(5)
    s_cmp_ge_u32 s93, 16
    s_cbranch_scc1 L_d234
    s_waitcnt vmcnt(4)
L_d234:
    buffer_load_dwordx4 v[136:139], v2, s[40:43], s45 offen offset:2048 nt
    v_mfma_f32_16x16x32_bf16 v[32:35], v[8:11], v[112:115], v[32:35]
    v_and_b32_dpp v20, v42, v4 row_newbcast:13 row_mask:0xf bank_mask:0xf
    v_and_b32_dpp v21, v42, v5 row_newbcast:13 row_mask:0xf bank_mask:0xf
    v_and_b32_dpp v22, v42, v6 row_newbcast:13 row_mask:0xf bank_mask:0xf
    v_and_b32_dpp v23, v42, v7 row_newbcast:13 row_mask:0xf bank_mask:0xf
    s_waitcnt vmcnt(5)
    s_cmp_ge_u32 s93, 16
    s_cbranch_scc1 L_d235
    s_waitcnt vmcnt(4)
L_d235:
    buffer_load_dwordx4 v[140:143], v2, s[40:43], s45 offen offset:3072 nt
    s_add_u32 s45, s45, 16384
    v_mfma_f32_16x16x32_bf16 v[32:35], v[12:15], v[116:119], v[32:35]
    v_and_b32_dpp v8, v42, v4 row_newbcast:2 row_mask:0xf bank_mask:0xf
    v_and_b32_dpp v9, v42, v5 row_newbcast:2 row_mask:0xf bank_mask:0xf
    v_and_b32_dpp v10, v42, v6 row_newbcast:2 row_mask:0xf bank_mask:0xf
    v_and_b32_dpp v11, v42, v7 row_newbcast:2 row_mask:0xf bank_mask:0xf
    s_waitcnt vmcnt(5)
    s_cmp_ge_u32 s93, 16
    s_cbranch_scc1 L_d236
    s_waitcnt vmcnt(4)
L_d236:
    buffer_load_dwordx4 v[144:147], v2, s[40:43], s45 offen offset:0 nt
    v_mfma_f32_16x16x32_bf16 v[32:35], v[16:19], v[120:123], v[32:35]
    v_and_b32_dpp v12, v42, v4 row_newbcast:6 row_mask:0xf bank_mask:0xf
    v_and_b32_dpp v13, v42, v5 row_newbcast:6 row_mask:0xf bank_mask:0xf
    v_and_b32_dpp v14, v42, v6 row_newbcast:6 row_mask:0xf bank_mask:0xf
    v_and_b32_dpp v15, v42, v7 row_newbcast:6 row_mask:0xf bank_mask:0xf
    s_waitcnt vmcnt(5)
    s_cmp_ge_u32 s93, 16
    s_cbranch_scc1 L_d237
    s_waitcnt vmcnt(4)
L_d237:
    buffer_load_dwordx4 v[148:151], v2, s[40:43], s45 offen offset:1024 nt
    v_mfma_f32_16x16x32_bf16 v[32:35], v[20:23], v[124:127], v[32:35]
    v_and_b32_dpp v16, v42, v4 row_newbcast:10 row_mask:0xf bank_mask:0xf
    v_and_b32_dpp v17, v42, v5 row_newbcast:10 row_mask:0xf bank_mask:0xf
    v_and_b32_dpp v18, v42, v6 row_newbcast:10 row_mask:0xf bank_mask:0xf
    v_and_b32_dpp v19, v42, v7 row_newbcast:10 row_mask:0xf bank_mask:0xf
    s_waitcnt vmcnt(5)
    s_cmp_ge_u32 s93, 16
    s_cbranch_scc1 L_d238
    s_waitcnt vmcnt(4)
L_d238:
    buffer_load_dwordx4 v[152:155], v2, s[40:43], s45 offen offset:2048 nt
    s_mov_b32 s32, 865280
    buffer_load_dword v47, v48, s[48:51], s32 offen nt
    v_mfma_f32_16x16x32_bf16 v[32:35], v[8:11], v[128:131], v[32:35]
    v_and_b32_dpp v20, v42, v4 row_newbcast:14 row_mask:0xf bank_mask:0xf
    v_and_b32_dpp v21, v42, v5 row_newbcast:14 row_mask:0xf bank_mask:0xf
    v_and_b32_dpp v22, v42, v6 row_newbcast:14 row_mask:0xf bank_mask:0xf
    v_and_b32_dpp v23, v42, v7 row_newbcast:14 row_mask:0xf bank_mask:0xf
    s_waitcnt vmcnt(6)
    s_cmp_ge_u32 s93, 16
    s_cbranch_scc1 L_d239
    s_waitcnt vmcnt(5)
L_d239:
    buffer_load_dwordx4 v[156:159], v2, s[40:43], s45 offen offset:3072 nt
    s_add_u32 s45, s45, 49152
    s_waitcnt vmcnt(6)
    s_cmp_ge_u32 s93, 16
    s_cbranch_scc1 L_d240
    s_waitcnt vmcnt(5)
L_d240:
    buffer_load_dwordx4 v[160:163], v2, s[40:43], s45 offen offset:0 nt
    s_mov_b32 s32, 865280
    buffer_store_dword v60, v49, s[48:51], s32 offen
    v_mfma_f32_16x16x32_bf16 v[32:35], v[12:15], v[132:135], v[32:35]
    v_and_b32_dpp v8, v42, v4 row_newbcast:3 row_mask:0xf bank_mask:0xf
    v_and_b32_dpp v9, v42, v5 row_newbcast:3 row_mask:0xf bank_mask:0xf
    v_and_b32_dpp v10, v42, v6 row_newbcast:3 row_mask:0xf bank_mask:0xf
    v_and_b32_dpp v11, v42, v7 row_newbcast:3 row_mask:0xf bank_mask:0xf
    s_waitcnt vmcnt(7)
    s_cmp_ge_u32 s93, 16
    s_cbranch_scc1 L_d241
    s_waitcnt vmcnt(6)
L_d241:
    buffer_load_dwordx4 v[164:167], v2, s[40:43], s45 offen offset:1024 nt
    s_waitcnt vmcnt(7)
    s_cmp_ge_u32 s93, 16
    s_cbranch_scc1 L_d242
    s_waitcnt vmcnt(6)
L_d242:
    buffer_load_dwordx4 v[168:171], v2, s[40:43], s45 offen offset:2048 nt
    v_mfma_f32_16x16x32_bf16 v[32:35], v[16:19], v[136:139], v[32:35]
    v_and_b32_dpp v12, v42, v4 row_newbcast:7 row_mask:0xf bank_mask:0xf
    v_and_b32_dpp v13, v42, v5 row_newbcast:7 row_mask:0xf bank_mask:0xf
    v_and_b32_dpp v14, v42, v6 row_newbcast:7 row_mask:0xf bank_mask:0xf
    v_and_b32_dpp v15, v42, v7 row_newbcast:7 row_mask:0xf bank_mask:0xf
    s_waitcnt vmcnt(7)
    s_cmp_ge_u32 s93, 16
    s_cbranch_scc1 L_d243
    s_waitcnt vmcnt(6)
    s_cmp_lt_i32 s95, -15
    s_cbranch_scc0 L_d243
    s_waitcnt vmcnt(4)
L_d243:
    buffer_load_dwordx4 v[172:175], v2, s[40:43], s45 offen offset:3072 nt
    s_add_u32 s45, s45, 16384
    v_mfma_f32_16x16x32_bf16 v[32:35], v[20:23], v[140:143], v[32:35]
    v_and_b32_dpp v16, v42, v4 row_newbcast:11 row_mask:0xf bank_mask:0xf
    v_and_b32_dpp v17, v42, v5 row_newbcast:11 row_mask:0xf bank_mask:0xf
    v_and_b32_dpp v18, v42, v6 row_newbcast:11 row_mask:0xf bank_mask:0xf
    v_and_b32_dpp v19, v42, v7 row_newbcast:11 row_mask:0xf bank_mask:0xf
    s_waitcnt vmcnt(7)
    s_cmp_ge_u32 s93, 16
    s_cbranch_scc1 L_d244
    s_waitcnt vmcnt(5)
L_d244:
    buffer_load_dwordx4 v[176:179], v2, s[40:43], s45 offen offset:0 nt
    v_mfma_f32_16x16x32_bf16 v[32:35], v[8:11], v[144:147], v[32:35]
    v_and_b32_dpp v20, v42, v4 row_newbcast:15 row_mask:0xf bank_mask:0xf
    v_and_b32_dpp v21, v42, v5 row_newbcast:15 row_mask:0xf bank_mask:0xf
    v_and_b32_dpp v22, v42, v6 row_newbcast:15 row_mask:0xf bank_mask:0xf
    v_and_b32_dpp v23, v42, v7 row_newbcast:15 row_mask:0xf bank_mask:0xf
    s_waitcnt vmcnt(6)
    s_cmp_ge_u32 s93, 16
    s_cbranch_scc1 L_d245
    s_waitcnt vmcnt(5)
L_d245:
    buffer_load_dwordx4 v[180:183], v2, s[40:43], s45 offen offset:1024 nt
    v_mfma_f32_16x16x32_bf16 v[32:35], v[12:15], v[148:151], v[32:35]
    v_and_b32_dpp v8, v43, v4 row_newbcast:0 row_mask:0xf bank_mask:0xf
    v_and_b32_dpp v9, v43, v5 row_newbcast:0 row_mask:0xf bank_mask:0xf
    v_and_b32_dpp v10, v43, v6 row_newbcast:0 row_mask:0xf bank_mask:0xf
    v_and_b32_dpp v11, v43, v7 row_newbcast:0 row_mask:0xf bank_mask:0xf
    v_mfma_f32_16x16x32_bf16 v[32:35], v[16:19], v[152:155], v[32:35]
    v_and_b32_dpp v12, v43, v4 row_newbcast:4 row_mask:0xf bank_mask:0xf
    v_and_b32_dpp v13, v43, v5 row_newbcast:4 row_mask:0xf bank_mask:0xf
    v_and_b32_dpp v14, v43, v6 row_newbcast:4 row_mask:0xf bank_mask:0xf
    v_and_b32_dpp v15, v43, v7 row_newbcast:4 row_mask:0xf bank_mask:0xf
    s_waitcnt vmcnt(6)
    s_cmp_ge_u32 s93, 16
    s_cbranch_scc1 L_d246
    s_waitcnt vmcnt(4)
L_d246:
    buffer_load_dwordx4 v[184:187], v2, s[40:43], s45 offen offset:2048 nt
    v_mfma_f32_16x16x32_bf16 v[32:35], v[20:23], v[156:159], v[32:35]
    v_and_b32_dpp v16, v43, v4 row_newbcast:8 row_mask:0xf bank_mask:0xf
    v_and_b32_dpp v17, v43, v5 row_newbcast:8 row_mask:0xf bank_mask:0xf
    v_and_b32_dpp v18, v43, v6 row_newbcast:8 row_mask:0xf bank_mask:0xf
    v_and_b32_dpp v19, v43, v7 row_newbcast:8 row_mask:0xf bank_mask:0xf
    s_waitcnt vmcnt(5)
    s_cmp_ge_u32 s93, 16
    s_cbranch_scc1 L_d247
    s_waitcnt vmcnt(4)
L_d247:
    buffer_load_dwordx4 v[188:191], v2, s[40:43], s45 offen offset:3072 nt
    s_add_u32 s45, s45, 49152
    v_cmp_eq_u32 vcc, v60, v47
    s_nop 0
    s_bcnt1_i32_b64 s93, vcc
    v_mfma_f32_16x16x32_bf16 v[32:35], v[8:11], v[160:163], v[32:35]
    v_and_b32_dpp v20, v43, v4 row_newbcast:12 row_mask:0xf bank_mask:0xf
    v_and_b32_dpp v21, v43, v5 row_newbcast:12 row_mask:0xf bank_mask:0xf
    v_and_b32_dpp v22, v43, v6 row_newbcast:12 row_mask:0xf bank_mask:0xf
    v_and_b32_dpp v23, v43, v7 row_newbcast:12 row_mask:0xf bank_mask:0xf
    v_mfma_f32_16x16x32_bf16 v[32:35], v[12:15], v[164:167], v[32:35]
    v_and_b32_dpp v8, v43, v4 row_newbcast:1 row_mask:0xf bank_mask:0xf
    v_and_b32_dpp v9, v43, v5 row_newbcast:1 row_mask:0xf bank_mask:0xf
    v_and_b32_dpp v10, v43, v6 row_newbcast:1 row_mask:0xf bank_mask:0xf
    v_and_b32_dpp v11, v43, v7 row_newbcast:1 row_mask:0xf bank_mask:0xf
    s_waitcnt vmcnt(5)
    s_cmp_ge_u32 s93, 16
    s_cbranch_scc1 L_d248
    s_waitcnt vmcnt(4)
L_d248:
    buffer_load_dwordx4 v[192:195], v2, s[40:43], s45 offen offset:0 nt
    v_mfma_f32_16x16x32_bf16 v[32:35], v[16:19], v[168:171], v[32:35]
    v_and_b32_dpp v12, v43, v4 row_newbcast:5 row_mask:0xf bank_mask:0xf
    v_and_b32_dpp v13, v43, v5 row_newbcast:5 row_mask:0xf bank_mask:0xf
    v_and_b32_dpp v14, v43, v6 row_newbcast:5 row_mask:0xf bank_mask:0xf
    v_and_b32_dpp v15, v43, v7 row_newbcast:5 row_mask:0xf bank_mask:0xf
    s_waitcnt vmcnt(5)
    s_cmp_ge_u32 s93, 16
    s_cbranch_scc1 L_d249
    s_waitcnt vmcnt(4)
L_d249:
    buffer_load_dwordx4 v[196:199], v2, s[40:43], s45 offen offset:1024 nt
    v_mfma_f32_16x16x32_bf16 v[32:35], v[20:23], v[172:175], v[32:35]
    v_and_b32_dpp v16, v43, v4 row_newbcast:9 row_mask:0xf bank_mask:0xf
    v_and_b32_dpp v17, v43, v5 row_newbcast:9 row_mask:0xf bank_mask:0xf
    v_and_b32_dpp v18, v43, v6 row_newbcast:9 row_mask:0xf bank_mask:0xf
    v_and_b32_dpp v19, v43, v7 row_newbcast:9 row_mask:0xf bank_mask:0xf
    s_waitcnt vmcnt(5)
    s_cmp_ge_u32 s93, 16
    s_cbranch_scc1 L_d250
    s_waitcnt vmcnt(4)
L_d250:
    buffer_load_dwordx4 v[200:203], v2, s[40:43], s45 offen offset:2048 nt
    v_mfma_f32_16x16x32_bf16 v[32:35], v[8:11], v[176:179], v[32:35]
    s_mov_b64 exec, 1
    ds_write_b32 v63, v63 offset:3400
    s_mov_b64 exec, -1
    v_and_b32_dpp v20, v43, v4 row_newbcast:13 row_mask:0xf bank_mask:0xf
    v_and_b32_dpp v21, v43, v5 row_newbcast:13 row_mask:0xf bank_mask:0xf
    v_and_b32_dpp v22, v43, v6 row_newbcast:13 row_mask:0xf bank_mask:0xf
    v_and_b32_dpp v23, v43, v7 row_newbcast:13 row_mask:0xf bank_mask:0xf
    s_waitcnt vmcnt(5)
    s_cmp_ge_u32 s93, 16
    s_cbranch_scc1 L_d251
    s_waitcnt vmcnt(4)
L_d251:
    buffer_load_dwordx4 v[204:207], v2, s[40:43], s45 offen offset:3072 nt
    s_add_u32 s45, s45, 16384
    v_mfma_f32_16x16x32_bf16 v[32:35], v[12:15], v[180:183], v[32:35]
    v_and_b32_dpp v8, v43, v4 row_newbcast:2 row_mask:0xf bank_mask:0xf
    v_and_b32_dpp v9, v43, v5 row_newbcast:2 row_mask:0xf bank_mask:0xf
    v_and_b32_dpp v10, v43, v6 row_newbcast:2 row_mask:0xf bank_mask:0xf
    v_and_b32_dpp v11, v43, v7 row_newbcast:2 row_mask:0xf bank_mask:0xf
    s_waitcnt vmcnt(5)
    s_cmp_ge_u32 s93, 16
    s_cbranch_scc1 L_d252
    s_waitcnt vmcnt(4)
L_d252:
    buffer_load_dwordx4 v[208:211], v2, s[40:43], s45 offen offset:0 nt
    v_mfma_f32_16x16x32_bf16 v[32:35], v[16:19], v[184:187], v[32:35]
    v_and_b32_dpp v12, v43, v4 row_newbcast:6 row_mask:0xf bank_mask:0xf
    v_and_b32_dpp v13, v43, v5 row_newbcast:6 row_mask:0xf bank_mask:0xf
    v_and_b32_dpp v14, v43, v6 row_newbcast:6 row_mask:0xf bank_mask:0xf
    v_and_b32_dpp v15, v43, v7 row_newbcast:6 row_mask:0xf bank_mask:0xf
    s_waitcnt vmcnt(5)
    s_cmp_ge_u32 s93, 16
    s_cbranch_scc1 L_d253
    s_waitcnt vmcnt(4)
L_d253:
    buffer_load_dwordx4 v[212:215], v2, s[40:43], s45 offen offset:1024 nt
    v_mfma_f32_16x16x32_bf16 v[32:35], v[20:23], v[188:191], v[32:35]
    v_and_b32_dpp v16, v43, v4 row_newbcast:10 row_mask:0xf bank_mask:0xf
    v_and_b32_dpp v17, v43, v5 row_newbcast:10 row_mask:0xf bank_mask:0xf
    v_and_b32_dpp v18, v43, v6 row_newbcast:10 row_mask:0xf bank_mask:0xf
    v_and_b32_dpp v19, v43, v7 row_newbcast:10 row_mask:0xf bank_mask:0xf
    s_waitcnt vmcnt(5)
    s_cmp_ge_u32 s93, 16
    s_cbranch_scc1 L_d254
    s_waitcnt vmcnt(4)
L_d254:
    buffer_load_dwordx4 v[216:219], v2, s[40:43], s45 offen offset:2048 nt
    v_mfma_f32_16x16x32_bf16 v[32:35], v[8:11], v[192:195], v[32:35]
    v_and_b32_dpp v20, v43, v4 row_newbcast:14 row_mask:0xf bank_mask:0xf
    v_and_b32_dpp v21, v43, v5 row_newbcast:14 row_mask:0xf bank_mask:0xf
    v_and_b32_dpp v22, v43, v6 row_newbcast:14 row_mask:0xf bank_mask:0xf
    v_and_b32_dpp v23, v43, v7 row_newbcast:14 row_mask:0xf bank_mask:0xf
    s_waitcnt vmcnt(5)
    s_cmp_ge_u32 s93, 16
    s_cbranch_scc1 L_d255
    s_waitcnt vmcnt(4)
L_d255:
    buffer_load_dwordx4 v[220:223], v2, s[40:43], s45 offen offset:3072 nt
    v_mfma_f32_16x16x32_bf16 v[32:35], v[12:15], v[196:199], v[32:35]
    v_and_b32_dpp v8, v43, v4 row_newbcast:3 row_mask:0xf bank_mask:0xf
    v_and_b32_dpp v9, v43, v5 row_newbcast:3 row_mask:0xf bank_mask:0xf
    v_and_b32_dpp v10, v43, v6 row_newbcast:3 row_mask:0xf bank_mask:0xf
    v_and_b32_dpp v11, v43, v7 row_newbcast:3 row_mask:0xf bank_mask:0xf
    s_waitcnt vmcnt(5)
    v_mfma_f32_16x16x32_bf16 v[32:35], v[16:19], v[200:203], v[32:35]
    v_and_b32_dpp v12, v43, v4 row_newbcast:7 row_mask:0xf bank_mask:0xf
    v_and_b32_dpp v13, v43, v5 row_newbcast:7 row_mask:0xf bank_mask:0xf
    v_and_b32_dpp v14, v43, v6 row_newbcast:7 row_mask:0xf bank_mask:0xf
    v_and_b32_dpp v15, v43, v7 row_newbcast:7 row_mask:0xf bank_mask:0xf
    s_waitcnt vmcnt(4)
    v_mfma_f32_16x16x32_bf16 v[32:35], v[20:23], v[204:207], v[32:35]
    v_and_b32_dpp v16, v43, v4 row_newbcast:11 row_mask:0xf bank_mask:0xf
    v_and_b32_dpp v17, v43, v5 row_newbcast:11 row_mask:0xf bank_mask:0xf
    v_and_b32_dpp v18, v43, v6 row_newbcast:11 row_mask:0xf bank_mask:0xf
    v_and_b32_dpp v19, v43, v7 row_newbcast:11 row_mask:0xf bank_mask:0xf
    s_waitcnt vmcnt(3)
    v_mfma_f32_16x16x32_bf16 v[32:35], v[8:11], v[208:211], v[32:35]
    v_and_b32_dpp v20, v43, v4 row_newbcast:15 row_mask:0xf bank_mask:0xf
    v_and_b32_dpp v21, v43, v5 row_newbcast:15 row_mask:0xf bank_mask:0xf
    v_and_b32_dpp v22, v43, v6 row_newbcast:15 row_mask:0xf bank_mask:0xf
    v_and_b32_dpp v23, v43, v7 row_newbcast:15 row_mask:0xf bank_mask:0xf
    s_waitcnt vmcnt(2)
    v_mfma_f32_16x16x32_bf16 v[32:35], v[12:15], v[212:215], v[32:35]
    s_waitcnt vmcnt(1)
    v_mfma_f32_16x16x32_bf16 v[32:35], v[16:19], v[216:219], v[32:35]
    s_waitcnt vmcnt(0)
    v_mfma_f32_16x16x32_bf16 v[32:35], v[20:23], v[220:223], v[32:35]
    s_mov_b32 exec_hi, 0
    s_nop 6
    v_cvt_pk_bf16_f32 v32, v32, v33
    v_cvt_pk_bf16_f32 v33, v34, v35
    ds_write2_b32 v50, v32, v33 offset0:0 offset1:40
    s_mov_b32 exec_hi, -1
    s_cmp_lg_u32 s3, 0
    s_waitcnt lgkmcnt(0)
    s_barrier
    s_cbranch_scc1 L_end
    s_mov_b32 s32, 883712
    buffer_store_dword v60, v49, s[48:51], s32 offen
    buffer_load_ushort v18, v55, s[52:55], 0 offen
    s_mov_b32 s33, 24
L_gt:
    buffer_load_dword v54, v48, s[48:51], s32 offen nt
    s_waitcnt vmcnt(0)
    v_cmp_eq_u32 vcc, v60, v54
    s_nop 0
    s_bcnt1_i32_b64 s93, vcc
    s_cmp_ge_u32 s93, 30
    s_cbranch_scc1 L_gt_ok
    s_sub_u32 s33, s33, 1
    s_cmp_lg_u32 s33, 0
    s_cbranch_scc1 L_gt
L_gt_ok:
    s_mov_b32 exec_hi, 0xffffff
    s_mov_b32 s33, 1000000
L_ff:
    buffer_load_dwordx4 v[24:27], v58, s[48:51], s34 offen sc1
    s_waitcnt vmcnt(0)
    v_xor_b32 v24, v24, v62
    v_xor_b32 v25, v25, v62
    v_xor_b32 v26, v26, v62
    v_xor_b32 v27, v27, v62
    v_or3_b32 v59, v24, v25, v26
    v_or_b32 v59, v59, v27
    v_and_b32 v59, 0xff, v59
    v_cmp_ne_u32 vcc, 0, v59
    s_cbranch_vccz L_ff_ok
    s_sub_u32 s33, s33, 1
    s_cmp_lg_u32 s33, 0
    s_cbranch_scc1 L_ff
L_ff_ok:
    s_mov_b32 exec_hi, -1
    v_permlane32_swap_b32 v24, v25
    v_permlane32_swap_b32 v26, v27
    v_add_f32 v24, v24, v25
    v_add_f32 v26, v26, v27
    s_nop 1
    v_permlane16_swap_b32 v24, v26
    v_add_f32 v24, v24, v26
    s_nop 1
    v_add_f32_dpp v24, v24, v24 quad_perm:[2,3,0,1] row_mask:0xf bank_mask:0xf
    s_nop 1
    v_add_f32_dpp v24, v24, v24 row_ror:4 row_mask:0xf bank_mask:0xf
    s_nop 1
    v_add_f32_dpp v24, v24, v24 row_ror:8 row_mask:0xf bank_mask:0xf
    v_cvt_pk_bf16_f32 v24, v24, v24
    v_and_b32 v24, 0xffff0000, v24
    v_mul_f32 v20, 0xbfb8aa3b, v24
    v_exp_f32 v20, v20
    s_nop 0
    v_add_f32 v20, 1.0, v20
    v_rcp_f32 v20, v20
    s_nop 0
    v_mul_f32 v24, v24, v20
    v_cvt_pk_bf16_f32 v16, v24, v24
    v_and_b32 v16, 0xffff0000, v16
    s_mov_b32 s33, 1000000
L_poll:
    buffer_load_dwordx4 v[32:35], v58, s[48:51], s46 offen sc1
    buffer_load_dwordx4 v[36:39], v58, s[48:51], s47 offen sc1
    s_waitcnt vmcnt(0)
    v_xor_b32 v32, v32, v62
    v_xor_b32 v33, v33, v62
    v_xor_b32 v34, v34, v62
    v_xor_b32 v35, v35, v62
    v_xor_b32 v36, v36, v62
    v_xor_b32 v37, v37, v62
    v_xor_b32 v38, v38, v62
    v_xor_b32 v39, v39, v62
    v_or3_b32 v59, v32, v33, v34
    v_or3_b32 v59, v59, v35, v36
    v_or3_b32 v59, v59, v37, v38
    v_or_b32 v59, v59, v39
    v_and_b32 v59, 0xff, v59
    v_cmp_ne_u32 vcc, 0, v59
    s_cbranch_vccz L_poll_ok
    s_mov_b64 exec, vcc
    s_sub_u32 s33, s33, 1
    s_cmp_lg_u32 s33, 0
    s_cbranch_scc1 L_poll
L_poll_ok:
    s_mov_b64 exec, -1
    v_add_f32 v32, v32, v36
    v_add_f32 v33, v33, v37
    v_add_f32 v34, v34, v38
    v_add_f32 v35, v35, v39
    v_lshlrev_b32 v17, 16, v18
    v_permlane32_swap_b32 v32, v33
    v_permlane32_swap_b32 v34, v35
    v_add_f32 v32, v32, v33
    v_add_f32 v34, v34, v35
    s_nop 1
    v_permlane16_swap_b32 v32, v34
    v_add_f32 v32, v32, v34
    s_nop 1
    v_add_f32_dpp v32, v32, v32 quad_perm:[2,3,0,1] row_mask:0xf bank_mask:0xf
    s_nop 1
    v_add_f32_dpp v32, v32, v32 row_ror:4 row_mask:0xf bank_mask:0xf
    s_nop 1
    v_add_f32_dpp v32, v32, v32 row_ror:8 row_mask:0xf bank_mask:0xf
    v_cvt_pk_bf16_f32 v32, v32, v32
    v_and_b32 v32, 0xffff0000, v32
    v_mul_f32 v32, v32, v16
    v_cvt_pk_bf16_f32 v32, v32, v32
    v_and_b32 v32, 0xffff0000, v32
    v_add_f32 v32, v32, v17
    v_cvt_pk_bf16_f32 v32, v32, v32
    s_mov_b64 exec, s[60:61]
    buffer_store_short v32, v55, s[56:59], 0 offen
    s_endpgm
L_helper:
    v_mov_b32 v63, 0
    v_lshlrev_b32 v49, 10, v51
    v_lshl_add_u32 v49, v50, 4, v49
    s_mov_b32 s71, 0xffffff00
    v_and_b32 v3, 3, v0
    v_lshlrev_b32 v3, 2, v3
    v_and_b32 v52, 1, v0
    v_mov_b32 v53, 0xffff
    v_mov_b32 v54, 0xffff0000
    v_cmp_eq_u32 vcc, 1, v52
    v_bfe_u32 v52, v0, 1, 2
    s_nop 0
    v_cndmask_b32 v53, v53, v54, vcc
    v_cmp_eq_u32 vcc, 0, v52
    s_nop 1
    v_cndmask_b32 v4, 0, v53, vcc
    v_cmp_eq_u32 vcc, 1, v52
    s_nop 1
    v_cndmask_b32 v5, 0, v53, vcc
    v_cmp_eq_u32 vcc, 2, v52
    s_nop 1
    v_cndmask_b32 v6, 0, v53, vcc
    v_cmp_eq_u32 vcc, 3, v52
    s_nop 1
    v_cndmask_b32 v7, 0, v53, vcc
    s_mov_b32 s52, s26
    s_mov_b32 s53, s27
    s_mov_b32 s54, 1048576
    s_mov_b32 s55, 0x20000
    s_mul_i32 s46, s3, 2112
    v_lshl_add_u32 v48, v0, 3, s46
    s_lshl_b32 s46, s3, 7
    s_mul_i32 s47, s29, 2112
    s_add_u32 s46, s46, s47
    v_mul_u32_u24 v61, 528, v51
    v_add_u32 v61, s46, v61
    s_waitcnt vmcnt(2)
    buffer_load_dwordx4 v[72:75], v1, s[40:43], s44 offen
    s_add_u32 s44, s44, 0x8000
    s_waitcnt vmcnt(2)
    buffer_load_dwordx4 v[76:79], v1, s[40:43], s44 offen
    s_add_u32 s44, s44, 0x8000
    s_and_b32 s44, s44, 0xfffff
    s_waitcnt vmcnt(2)
    buffer_load_dwordx4 v[80:83], v1, s[40:43], s44 offen
    s_add_u32 s44, s44, 0x8000
    v_lshlrev_b32 v192, 16, v16
    v_and_b32 v193, 0xffff0000, v16
    v_lshlrev_b32 v194, 16, v17
    v_and_b32 v195, 0xffff0000, v17
    v_lshlrev_b32 v196, 16, v18
    v_and_b32 v197, 0xffff0000, v18
    v_lshlrev_b32 v198, 16, v19
    v_and_b32 v199, 0xffff0000, v19
    v_pk_add_f32 v[56:57], v[192:193], v[194:195]
    v_pk_add_f32 v[58:59], v[196:197], v[198:199]
    v_pk_add_f32 v[56:57], v[56:57], v[58:59]
    v_add_f32 v56, v56, v57
    s_nop 1
    v_add_f32_dpp v56, v56, v56 quad_perm:[1,0,3,2] row_mask:0xf bank_mask:0xf
    s_nop 1
    v_add_f32_dpp v56, v56, v56 quad_perm:[2,3,0,1] row_mask:0xf bank_mask:0xf
    s_nop 1
    v_add_f32_dpp v56, v56, v56 row_ror:4 row_mask:0xf bank_mask:0xf
    s_nop 1
    v_add_f32_dpp v56, v56, v56 row_ror:8 row_mask:0xf bank_mask:0xf
    v_mov_b32 v59, v56
    s_nop 1
    v_permlane16_swap_b32 v56, v59
    v_add_f32 v56, v56, v59
    v_mov_b32 v59, v56
    s_nop 1
    v_permlane32_swap_b32 v56, v59
    v_add_f32 v56, v56, v59
    v_mul_f32 v56, 0x3b000000, v56
    v_sub_f32 v59, v192, v56
    v_mul_f32 v57, v59, v59
    v_sub_f32 v59, v193, v56
    v_fmac_f32 v57, v59, v59
    v_sub_f32 v59, v194, v56
    v_fmac_f32 v57, v59, v59
    v_sub_f32 v59, v195, v56
    v_fmac_f32 v57, v59, v59
    v_sub_f32 v59, v196, v56
    v_fmac_f32 v57, v59, v59
    v_sub_f32 v59, v197, v56
    v_fmac_f32 v57, v59, v59
    v_sub_f32 v59, v198, v56
    v_fmac_f32 v57, v59, v59
    v_sub_f32 v59, v199, v56
    v_fmac_f32 v57, v59, v59
    s_nop 1
    v_add_f32_dpp v57, v57, v57 quad_perm:[1,0,3,2] row_mask:0xf bank_mask:0xf
    s_nop 1
    v_add_f32_dpp v57, v57, v57 quad_perm:[2,3,0,1] row_mask:0xf bank_mask:0xf
    s_nop 1
    v_add_f32_dpp v57, v57, v57 row_ror:4 row_mask:0xf bank_mask:0xf
    s_nop 1
    v_add_f32_dpp v57, v57, v57 row_ror:8 row_mask:0xf bank_mask:0xf
    v_mov_b32 v59, v57
    s_nop 1
    v_permlane16_swap_b32 v57, v59
    v_add_f32 v57, v57, v59
    v_mov_b32 v59, v57
    s_nop 1
    v_permlane32_swap_b32 v57, v59
    v_add_f32 v57, v57, v59
    v_mul_f32 v57, 0x3b000000, v57
    v_cvt_pk_bf16_f32 v56, v56, v56
    v_and_b32 v56, 0xffff0000, v56
    v_cvt_pk_bf16_f32 v57, v57, v57
    v_and_b32 v57, 0xffff0000, v57
    v_add_f32 v57, 0x3727c5ac, v57
    v_cvt_pk_bf16_f32 v57, v57, v57
    v_and_b32 v57, 0xffff0000, v57
    v_sqrt_f32 v57, v57
    s_nop 0
    v_cvt_pk_bf16_f32 v57, v57, v57
    v_and_b32 v57, 0xffff0000, v57
    v_rcp_f32 v58, v57
    s_waitcnt vmcnt(2)
    buffer_load_dwordx4 v[84:87], v1, s[40:43], s44 offen
    s_add_u32 s44, s44, 0x8000
    v_sub_f32 v16, v192, v56
    v_cvt_pk_bf16_f32 v16, v16, v16
    v_and_b32 v16, 0xffff0000, v16
    v_mul_f32 v59, v16, v58
    v_fma_f32 v60, -v59, v57, v16
    v_fma_f32 v59, v60, v58, v59
    v_cvt_pk_bf16_f32 v16, v59, v59
    v_sub_f32 v17, v196, v56
    v_cvt_pk_bf16_f32 v17, v17, v17
    v_and_b32 v17, 0xffff0000, v17
    v_mul_f32 v59, v17, v58
    v_fma_f32 v60, -v59, v57, v17
    v_fma_f32 v59, v60, v58, v59
    v_cvt_pk_bf16_f32 v17, v59, v59
    ds_write_b64 v48, v[16:17] offset:5120
    v_sub_f32 v18, v193, v56
    v_cvt_pk_bf16_f32 v18, v18, v18
    v_and_b32 v18, 0xffff0000, v18
    v_mul_f32 v59, v18, v58
    v_fma_f32 v60, -v59, v57, v18
    v_fma_f32 v59, v60, v58, v59
    v_cvt_pk_bf16_f32 v18, v59, v59
    v_sub_f32 v19, v197, v56
    v_cvt_pk_bf16_f32 v19, v19, v19
    v_and_b32 v19, 0xffff0000, v19
    v_mul_f32 v59, v19, v58
    v_fma_f32 v60, -v59, v57, v19
    v_fma_f32 v59, v60, v58, v59
    v_cvt_pk_bf16_f32 v19, v59, v59
    ds_write_b64 v48, v[18:19] offset:5648
    v_sub_f32 v20, v194, v56
    v_cvt_pk_bf16_f32 v20, v20, v20
    v_and_b32 v20, 0xffff0000, v20
    v_mul_f32 v59, v20, v58
    v_fma_f32 v60, -v59, v57, v20
    v_fma_f32 v59, v60, v58, v59
    v_cvt_pk_bf16_f32 v20, v59, v59
    v_sub_f32 v21, v198, v56
    v_cvt_pk_bf16_f32 v21, v21, v21
    v_and_b32 v21, 0xffff0000, v21
    v_mul_f32 v59, v21, v58
    v_fma_f32 v60, -v59, v57, v21
    v_fma_f32 v59, v60, v58, v59
    v_cvt_pk_bf16_f32 v21, v59, v59
    ds_write_b64 v48, v[20:21] offset:6176
    v_sub_f32 v22, v195, v56
    v_cvt_pk_bf16_f32 v22, v22, v22
    v_and_b32 v22, 0xffff0000, v22
    v_mul_f32 v59, v22, v58
    v_fma_f32 v60, -v59, v57, v22
    v_fma_f32 v59, v60, v58, v59
    v_cvt_pk_bf16_f32 v22, v59, v59
    v_sub_f32 v23, v199, v56
    v_cvt_pk_bf16_f32 v23, v23, v23
    v_and_b32 v23, 0xffff0000, v23
    v_mul_f32 v59, v23, v58
    v_fma_f32 v60, -v59, v57, v23
    v_fma_f32 v59, v60, v58, v59
    v_cvt_pk_bf16_f32 v23, v59, v59
    ds_write_b64 v48, v[22:23] offset:6704
    s_lshl_b32 s46, s3, 2
    v_mov_b32 v55, s46
    ds_write_b32 v55, v63 offset:3376
    s_waitcnt lgkmcnt(0)
    s_add_u32 s70, s70, 1
    s_and_b32 s70, s70, 0xff
    v_mov_b32 v62, s70
    s_waitcnt vmcnt(2)
    buffer_load_dwordx4 v[88:91], v1, s[40:43], s44 offen
    s_add_u32 s44, s44, 0x8000
    s_waitcnt vmcnt(2)
    buffer_load_dwordx4 v[92:95], v1, s[40:43], s44 offen
    s_add_u32 s44, s44, 0x8000
    s_and_b32 s44, s44, 0xfffff
    s_waitcnt vmcnt(2)
    buffer_load_dwordx4 v[96:99], v1, s[40:43], s44 offen
    s_add_u32 s44, s44, 0x8000
    s_waitcnt vmcnt(2)
    buffer_load_dwordx4 v[100:103], v1, s[40:43], s44 offen
    s_add_u32 s44, s44, 0x8000
    s_waitcnt vmcnt(2)
    buffer_load_dwordx4 v[104:107], v1, s[40:43], s44 offen
    s_add_u32 s44, s44, 0x8000
    s_waitcnt vmcnt(2)
    buffer_load_dwordx4 v[108:111], v1, s[40:43], s44 offen
    s_add_u32 s44, s44, 0x8000
    s_and_b32 s44, s44, 0xfffff
    s_mov_b32 s33, 1000000
L_tf:
    ds_read_b32 v59, v3 offset:3376
    s_waitcnt lgkmcnt(0)
    v_cmp_eq_u32 vcc, 0xbf800000, v59
    s_cbranch_vccz L_tf_ok
    s_sleep 1
    s_sub_u32 s33, s33, 1
    s_cmp_lg_u32 s33, 0
    s_cbranch_scc1 L_tf
L_tf_ok:
    s_add_u32 s46, s14, 0
    s_and_b32 s46, s46, 7
    s_lshl_b32 s46, s46, 4
    v_add_u32 v44, s46, v61
    ds_read_b128 v[192:195], v44 offset:5120
    s_add_u32 s46, s14, 1
    s_and_b32 s46, s46, 7
    s_lshl_b32 s46, s46, 4
    v_add_u32 v44, s46, v61
    ds_read_b128 v[196:199], v44 offset:5120
    s_add_u32 s46, s14, 2
    s_and_b32 s46, s46, 7
    s_lshl_b32 s46, s46, 4
    v_add_u32 v44, s46, v61
    ds_read_b128 v[200:203], v44 offset:5120
    s_add_u32 s46, s14, 3
    s_and_b32 s46, s46, 7
    s_lshl_b32 s46, s46, 4
    v_add_u32 v44, s46, v61
    ds_read_b128 v[204:207], v44 offset:5120
    s_add_u32 s46, s14, 4
    s_and_b32 s46, s46, 7
    s_lshl_b32 s46, s46, 4
    v_add_u32 v44, s46, v61
    ds_read_b128 v[208:211], v44 offset:5120
    s_add_u32 s46, s14, 5
    s_and_b32 s46, s46, 7
    s_lshl_b32 s46, s46, 4
    v_add_u32 v44, s46, v61
    ds_read_b128 v[212:215], v44 offset:5120
    s_add_u32 s46, s14, 6
    s_and_b32 s46, s46, 7
    s_lshl_b32 s46, s46, 4
    v_add_u32 v44, s46, v61
    ds_read_b128 v[216:219], v44 offset:5120
    s_add_u32 s46, s14, 7
    s_and_b32 s46, s46, 7
    s_lshl_b32 s46, s46, 4
    v_add_u32 v44, s46, v61
    ds_read_b128 v[220:223], v44 offset:5120
    s_waitcnt vmcnt(2)
    buffer_load_dwordx4 v[112:115], v1, s[40:43], s44 offen
    s_add_u32 s44, s44, 0x8000
    s_waitcnt lgkmcnt(0)
    v_and_b32 v224, v192, v4
    v_and_b32 v225, v192, v5
    v_and_b32 v226, v192, v6
    v_and_b32 v227, v192, v7
    v_and_b32 v228, v193, v4
    v_and_b32 v229, v193, v5
    v_and_b32 v230, v193, v6
    v_and_b32 v231, v193, v7
    s_waitcnt vmcnt(2)
    buffer_load_dwordx4 v[116:119], v1, s[40:43], s44 offen
    s_add_u32 s44, s44, 0x8000
    v_mfma_f32_16x16x32_bf16 v[8:11], v[224:227], v[64:67], 0
    v_and_b32 v232, v194, v4
    v_and_b32 v233, v194, v5
    v_and_b32 v234, v194, v6
    v_and_b32 v235, v194, v7
    v_mfma_f32_16x16x32_bf16 v[8:11], v[228:231], v[68:71], v[8:11]
    v_and_b32 v236, v195, v4
    v_and_b32 v237, v195, v5
    v_and_b32 v238, v195, v6
    v_and_b32 v239, v195, v7
    v_mfma_f32_16x16x32_bf16 v[8:11], v[232:235], v[72:75], v[8:11]
    v_and_b32 v224, v196, v4
    v_and_b32 v225, v196, v5
    v_and_b32 v226, v196, v6
    v_and_b32 v227, v196, v7
    s_waitcnt vmcnt(2)
    buffer_load_dwordx4 v[120:123], v1, s[40:43], s44 offen
    s_add_u32 s44, s44, 0x8000
    v_mfma_f32_16x16x32_bf16 v[8:11], v[236:239], v[76:79], v[8:11]
    v_and_b32 v228, v197, v4
    v_and_b32 v229, v197, v5
    v_and_b32 v230, v197, v6
    v_and_b32 v231, v197, v7
    v_mfma_f32_16x16x32_bf16 v[8:11], v[224:227], v[80:83], v[8:11]
    v_and_b32 v232, v198, v4
    v_and_b32 v233, v198, v5
    v_and_b32 v234, v198, v6
    v_and_b32 v235, v198, v7
    v_mfma_f32_16x16x32_bf16 v[8:11], v[228:231], v[84:87], v[8:11]
    v_and_b32 v236, v199, v4
    v_and_b32 v237, v199, v5
    v_and_b32 v238, v199, v6
    v_and_b32 v239, v199, v7
    s_waitcnt vmcnt(2)
    buffer_load_dwordx4 v[124:127], v1, s[40:43], s44 offen
    s_add_u32 s44, s44, 0x8000
    s_and_b32 s44, s44, 0xfffff
    v_mfma_f32_16x16x32_bf16 v[8:11], v[232:235], v[88:91], v[8:11]
    v_and_b32 v224, v200, v4
    v_and_b32 v225, v200, v5
    v_and_b32 v226, v200, v6
    v_and_b32 v227, v200, v7
    v_mfma_f32_16x16x32_bf16 v[8:11], v[236:239], v[92:95], v[8:11]
    v_and_b32 v228, v201, v4
    v_and_b32 v229, v201, v5
    v_and_b32 v230, v201, v6
    v_and_b32 v231, v201, v7
    v_mfma_f32_16x16x32_bf16 v[8:11], v[224:227], v[96:99], v[8:11]
    v_and_b32 v232, v202, v4
    v_and_b32 v233, v202, v5
    v_and_b32 v234, v202, v6
    v_and_b32 v235, v202, v7
    s_waitcnt vmcnt(2)
    buffer_load_dwordx4 v[128:131], v1, s[40:43], s44 offen
    s_add_u32 s44, s44, 0x8000
    v_mfma_f32_16x16x32_bf16 v[8:11], v[228:231], v[100:103], v[8:11]
    v_and_b32 v236, v203, v4
    v_and_b32 v237, v203, v5
    v_and_b32 v238, v203, v6
    v_and_b32 v239, v203, v7
    v_mfma_f32_16x16x32_bf16 v[8:11], v[232:235], v[104:107], v[8:11]
    v_and_b32 v224, v204, v4
    v_and_b32 v225, v204, v5
    v_and_b32 v226, v204, v6
    v_and_b32 v227, v204, v7
    v_mfma_f32_16x16x32_bf16 v[8:11], v[236:239], v[108:111], v[8:11]
    v_and_b32 v228, v205, v4
    v_and_b32 v229, v205, v5
    v_and_b32 v230, v205, v6
    v_and_b32 v231, v205, v7
    s_waitcnt vmcnt(2)
    buffer_load_dwordx4 v[132:135], v1, s[40:43], s44 offen
    s_add_u32 s44, s44, 0x8000
    v_mfma_f32_16x16x32_bf16 v[8:11], v[224:227], v[112:115], v[8:11]
    v_and_b32 v232, v206, v4
    v_and_b32 v233, v206, v5
    v_and_b32 v234, v206, v6
    v_and_b32 v235, v206, v7
    v_mfma_f32_16x16x32_bf16 v[8:11], v[228:231], v[116:119], v[8:11]
    v_and_b32 v236, v207, v4
    v_and_b32 v237, v207, v5
    v_and_b32 v238, v207, v6
    v_and_b32 v239, v207, v7
    v_mfma_f32_16x16x32_bf16 v[8:11], v[232:235], v[120:123], v[8:11]
    v_and_b32 v224, v208, v4
    v_and_b32 v225, v208, v5
    v_and_b32 v226, v208, v6
    v_and_b32 v227, v208, v7
    s_waitcnt vmcnt(2)
    buffer_load_dwordx4 v[136:139], v1, s[40:43], s44 offen
    s_add_u32 s44, s44, 0x8000
    v_mfma_f32_16x16x32_bf16 v[8:11], v[236:239], v[124:127], v[8:11]
    v_and_b32 v228, v209, v4
    v_and_b32 v229, v209, v5
    v_and_b32 v230, v209, v6
    v_and_b32 v231, v209, v7
    s_waitcnt vmcnt(2)
    buffer_load_dwordx4 v[140:143], v1, s[40:43], s44 offen
    s_add_u32 s44, s44, 0x8000
    s_and_b32 s44, s44, 0xfffff
    v_mfma_f32_16x16x32_bf16 v[8:11], v[224:227], v[128:131], v[8:11]
    v_and_b32 v232, v210, v4
    v_and_b32 v233, v210, v5
    v_and_b32 v234, v210, v6
    v_and_b32 v235, v210, v7
    s_waitcnt vmcnt(2)
    buffer_load_dwordx4 v[144:147], v1, s[40:43], s44 offen
    s_add_u32 s44, s44, 0x8000
    v_mfma_f32_16x16x32_bf16 v[8:11], v[228:231], v[132:135], v[8:11]
    v_and_b32 v236, v211, v4
    v_and_b32 v237, v211, v5
    v_and_b32 v238, v211, v6
    v_and_b32 v239, v211, v7
    s_waitcnt vmcnt(2)
    buffer_load_dwordx4 v[148:151], v1, s[40:43], s44 offen
    s_add_u32 s44, s44, 0x8000
    v_mfma_f32_16x16x32_bf16 v[8:11], v[232:235], v[136:139], v[8:11]
    v_and_b32 v224, v212, v4
    v_and_b32 v225, v212, v5
    v_and_b32 v226, v212, v6
    v_and_b32 v227, v212, v7
    s_waitcnt vmcnt(2)
    buffer_load_dwordx4 v[152:155], v1, s[40:43], s44 offen
    s_add_u32 s44, s44, 0x8000
    v_mfma_f32_16x16x32_bf16 v[8:11], v[236:239], v[140:143], v[8:11]
    v_and_b32 v228, v213, v4
    v_and_b32 v229, v213, v5
    v_and_b32 v230, v213, v6
    v_and_b32 v231, v213, v7
    s_waitcnt vmcnt(2)
    buffer_load_dwordx4 v[156:159], v1, s[40:43], s44 offen
    s_add_u32 s44, s44, 0x8000
    s_and_b32 s44, s44, 0xfffff
    v_mfma_f32_16x16x32_bf16 v[8:11], v[224:227], v[144:147], v[8:11]
    v_and_b32 v232, v214, v4
    v_and_b32 v233, v214, v5
    v_and_b32 v234, v214, v6
    v_and_b32 v235, v214, v7
    s_waitcnt vmcnt(2)
    buffer_load_dwordx4 v[160:163], v1, s[40:43], s44 offen
    s_add_u32 s44, s44, 0x8000
    v_mfma_f32_16x16x32_bf16 v[8:11], v[228:231], v[148:151], v[8:11]
    v_and_b32 v236, v215, v4
    v_and_b32 v237, v215, v5
    v_and_b32 v238, v215, v6
    v_and_b32 v239, v215, v7
    s_waitcnt vmcnt(2)
    buffer_load_dwordx4 v[164:167], v1, s[40:43], s44 offen
    s_add_u32 s44, s44, 0x8000
    v_mfma_f32_16x16x32_bf16 v[8:11], v[232:235], v[152:155], v[8:11]
    v_and_b32 v224, v216, v4
    v_and_b32 v225, v216, v5
    v_and_b32 v226, v216, v6
    v_and_b32 v227, v216, v7
    s_waitcnt vmcnt(2)
    buffer_load_dwordx4 v[168:171], v1, s[40:43], s44 offen
    s_add_u32 s44, s44, 0x8000
    v_mfma_f32_16x16x32_bf16 v[8:11], v[236:239], v[156:159], v[8:11]
    v_and_b32 v228, v217, v4
    v_and_b32 v229, v217, v5
    v_and_b32 v230, v217, v6
    v_and_b32 v231, v217, v7
    s_waitcnt vmcnt(2)
    buffer_load_dwordx4 v[172:175], v1, s[40:43], s44 offen
    s_add_u32 s44, s44, 0x8000
    s_and_b32 s44, s44, 0xfffff
    v_mfma_f32_16x16x32_bf16 v[8:11], v[224:227], v[160:163], v[8:11]
    v_and_b32 v232, v218, v4
    v_and_b32 v233, v218, v5
    v_and_b32 v234, v218, v6
    v_and_b32 v235, v218, v7
    s_waitcnt vmcnt(2)
    buffer_load_dwordx4 v[176:179], v1, s[40:43], s44 offen
    s_add_u32 s44, s44, 0x8000
    v_mfma_f32_16x16x32_bf16 v[8:11], v[228:231], v[164:167], v[8:11]
    v_and_b32 v236, v219, v4
    v_and_b32 v237, v219, v5
    v_and_b32 v238, v219, v6
    v_and_b32 v239, v219, v7
    s_waitcnt vmcnt(2)
    buffer_load_dwordx4 v[180:183], v1, s[40:43], s44 offen
    s_add_u32 s44, s44, 0x8000
    v_mfma_f32_16x16x32_bf16 v[8:11], v[232:235], v[168:171], v[8:11]
    v_and_b32 v224, v220, v4
    v_and_b32 v225, v220, v5
    v_and_b32 v226, v220, v6
    v_and_b32 v227, v220, v7
    s_waitcnt vmcnt(2)
    buffer_load_dwordx4 v[184:187], v1, s[40:43], s44 offen
    s_add_u32 s44, s44, 0x8000
    v_mfma_f32_16x16x32_bf16 v[8:11], v[236:239], v[172:175], v[8:11]
    v_and_b32 v228, v221, v4
    v_and_b32 v229, v221, v5
    v_and_b32 v230, v221, v6
    v_and_b32 v231, v221, v7
    s_waitcnt vmcnt(2)
    buffer_load_dwordx4 v[188:191], v1, s[40:43], s44 offen
    v_mfma_f32_16x16x32_bf16 v[8:11], v[224:227], v[176:179], v[8:11]
    v_and_b32 v232, v222, v4
    v_and_b32 v233, v222, v5
    v_and_b32 v234, v222, v6
    v_and_b32 v235, v222, v7
    v_lshlrev_b32 v52, 5, v50
    v_lshl_add_u32 v52, v51, 4, v52
    s_lshl_b32 s46, s3, 9
    v_add_u32 v52, s46, v52
    s_waitcnt vmcnt(2)
    v_mfma_f32_16x16x32_bf16 v[8:11], v[228:231], v[180:183], v[8:11]
    v_and_b32 v236, v223, v4
    v_and_b32 v237, v223, v5
    v_and_b32 v238, v223, v6
    v_and_b32 v239, v223, v7
    s_waitcnt vmcnt(1)
    v_mfma_f32_16x16x32_bf16 v[8:11], v[232:235], v[184:187], v[8:11]
    s_waitcnt vmcnt(0)
    v_mfma_f32_16x16x32_bf16 v[8:11], v[236:239], v[188:191], v[8:11]
    s_mov_b32 exec_hi, 0
    s_nop 6
    ds_write_b128 v52, v[8:11] offset:0
    ds_write_b32 v55, v63 offset:3360
    s_mov_b32 exec_hi, -1
    s_lshl_b32 s31, s31, 1
    s_add_u32 s31, s31, s30
    s_mov_b32 s35, 0
    s_getpc_b64 s[46:47]
L_pc:
    s_sub_u32 s46, s46, L_pc-recurrent_scan__mha_block_cached__glu_gated_reglu__decode_kernel
    s_subb_u32 s47, s47, 0
    s_lshl2_add_u32 s45, s66, s3
    s_lshl_b32 s45, s45, 8
    v_lshl_add_u32 v44, v0, 7, s45
    v_min_u32 v44, L_end-recurrent_scan__mha_block_cached__glu_gated_reglu__decode_kernel, v44
    v_mov_b32 v45, s47
    v_add_co_u32 v44, vcc, s46, v44
    s_nop 1
    v_addc_co_u32 v45, vcc, 0, v45, vcc
    s_mov_b64 exec, 3
    global_load_dword v46, v[44:45], off
    s_mov_b64 exec, -1
    s_cmp_lg_u32 s3, 3
    s_cbranch_scc1 L_nopub
    s_mov_b32 s35, 1
    v_lshlrev_b32 v53, 1, v3
    s_mov_b32 s33, 1000000
L_ml:
    ds_read_b32 v59, v53 offset:3332
    s_waitcnt lgkmcnt(0)
    v_cmp_eq_u32 vcc, 0xbf800000, v59
    s_cbranch_vccz L_ml_ok
    s_sleep 8
    s_sub_u32 s33, s33, 1
    s_cmp_lg_u32 s33, 0
    s_cbranch_scc1 L_ml
L_ml_ok:
    ds_read_b64 v[16:17], v53 offset:3328
    s_waitcnt lgkmcnt(0)
    v_max_f32_dpp v20, v16, v16 quad_perm:[1,0,3,2] row_mask:0xf bank_mask:0xf
    s_nop 1
    v_max_f32_dpp v20, v20, v20 quad_perm:[2,3,0,1] row_mask:0xf bank_mask:0xf
    v_sub_f32 v18, v16, v20
    v_mul_f32 v18, 0x3fb8aa3b, v18
    v_exp_f32 v18, v18
    s_nop 0
    v_mul_f32 v21, v17, v18
    s_nop 1
    v_add_f32_dpp v21, v21, v21 quad_perm:[1,0,3,2] row_mask:0xf bank_mask:0xf
    s_nop 1
    v_add_f32_dpp v21, v21, v21 quad_perm:[2,3,0,1] row_mask:0xf bank_mask:0xf
    v_mov_b32 v24, v20
    v_mov_b32 v25, v21
    v_mov_b32 v26, v20
    v_mov_b32 v27, v21
    v_and_or_b32 v24, v24, s71, v62
    v_and_or_b32 v25, v25, s71, v62
    v_and_or_b32 v26, v26, s71, v62
    v_and_or_b32 v27, v27, s71, v62
    s_lshl_b32 s44, s31, 7
    s_add_u32 s44, s44, 786432
    s_xor_b32 s69, s44, 128
    s_mov_b64 exec, 0xff
    buffer_store_dwordx4 v[24:27], v2, s[52:55], s44 offen sc1
    s_mov_b64 exec, -1
L_nopub:
    s_cmp_eq_u32 s67, 0
    s_cbranch_scc1 L_noffn
    s_cmp_lg_u32 s30, 0
    s_cbranch_scc1 L_noffn
    s_lshr_b32 s68, s66, 1
    s_mov_b32 s35, 1
    s_cmp_eq_u32 s3, 1
    s_cbranch_scc1 L_ffn
    s_mov_b32 s33, 1000000
L_sf:
    ds_read_b32 v59, v63 offset:3396
    s_waitcnt lgkmcnt(0)
    v_cmp_eq_u32 vcc, 0xbf800000, v59
    s_cbranch_vccz L_sf_ok
    s_sleep 16
    s_sub_u32 s33, s33, 1
    s_cmp_lg_u32 s33, 0
    s_cbranch_scc1 L_sf
L_sf_ok:
    s_branch L_noffn
L_ffn:
    s_and_b32 s69, s68, 3
    s_lshl_b32 s32, s67, 2
    s_lshr_b32 s67, 0x54326100, s32
    s_and_b32 s67, s67, 15
    s_lshr_b32 s33, s66, 3
    s_lshl2_add_u32 s68, s67, s33
    s_mul_i32 s44, s68, 86
    s_lshr_b32 s44, s44, 8
    s_add_u32 s44, s44, s68
    s_lshl_b32 s15, s68, 2
    s_sub_u32 s15, s15, 81
    s_cmp_lt_u32 s68, 21
    s_cselect_b32 s68, s44, s15
    v_cmp_gt_u32 vcc, 8, v50
    v_mov_b32 v14, s18
    v_mov_b32 v15, s19
    v_mov_b32 v52, s16
    v_mov_b32 v53, s17
    v_cndmask_b32 v32, v14, v52, vcc
    v_cndmask_b32 v33, v15, v53, vcc
    v_and_b32 v52, 7, v0
    v_lshlrev_b32 v52, 4, v52
    v_mul_u32_u24 v53, 3584, v51
    v_add_u32 v52, v52, v53
    s_lshl_b32 s46, s68, 7
    v_add_u32 v52, s46, v52
    v_add_co_u32 v32, vcc, v32, v52
    s_nop 1
    v_addc_co_u32 v33, vcc, 0, v33, vcc
    s_mov_b32 s64, 14336
    s_mov_b32 s65, 0
    global_load_dwordx4 v[64:67], v[32:33], off
    v_lshl_add_u64 v[32:33], v[32:33], 0, s[64:65]
    global_load_dwordx4 v[68:71], v[32:33], off
    v_lshl_add_u64 v[32:33], v[32:33], 0, s[64:65]
    global_load_dwordx4 v[72:75], v[32:33], off
    v_lshl_add_u64 v[32:33], v[32:33], 0, s[64:65]
    global_load_dwordx4 v[76:79], v[32:33], off
    v_lshl_add_u64 v[32:33], v[32:33], 0, s[64:65]
    global_load_dwordx4 v[80:83], v[32:33], off
    v_lshl_add_u64 v[32:33], v[32:33], 0, s[64:65]
    global_load_dwordx4 v[84:87], v[32:33], off
    v_lshl_add_u64 v[32:33], v[32:33], 0, s[64:65]
    global_load_dwordx4 v[88:91], v[32:33], off
    v_lshl_add_u64 v[32:33], v[32:33], 0, s[64:65]
    global_load_dwordx4 v[92:95], v[32:33], off
    v_lshl_add_u64 v[32:33], v[32:33], 0, s[64:65]
    s_mov_b32 s56, s20
    s_mov_b32 s57, s21
    s_mov_b32 s58, 1835008
    s_mov_b32 s59, 0x20000
    s_lshl_b32 s44, s68, 16
    s_lshl_b32 s45, s69, 8
    s_add_u32 s44, s44, s45
    v_lshrrev_b32 v52, 3, v50
    v_lshl_add_u32 v52, v52, 2, v51
    v_mul_u32_u24 v54, 528, v52
    v_mul_u32_u24 v61, 80, v52
    v_mov_b32 v8, 0
    v_mov_b32 v9, 0
    v_mov_b32 v10, 0
    v_mov_b32 v11, 0
    v_mov_b32 v12, 0
    v_mov_b32 v13, 0
    v_mov_b32 v14, 0
    v_mov_b32 v15, 0
    s_mov_b32 s45, 15
L_gu:
    ds_read_b128 v[16:19], v54 offset:5120
    ds_read_b128 v[20:23], v54 offset:9344
    ds_read_b128 v[24:27], v54 offset:5136
    ds_read_b128 v[28:31], v54 offset:9360
    v_add_u32 v54, 32, v54
    s_waitcnt lgkmcnt(0)
    v_and_b32 v224, v16, v4
    v_and_b32 v225, v16, v5
    v_and_b32 v226, v16, v6
    v_and_b32 v227, v16, v7
    v_and_b32 v228, v20, v4
    v_and_b32 v229, v20, v5
    v_and_b32 v230, v20, v6
    v_and_b32 v231, v20, v7
    s_waitcnt vmcnt(7)
    v_mfma_f32_16x16x32_bf16 v[8:11], v[224:227], v[64:67], v[8:11]
    v_mfma_f32_16x16x32_bf16 v[12:15], v[228:231], v[64:67], v[12:15]
    global_load_dwordx4 v[64:67], v[32:33], off
    v_lshl_add_u64 v[32:33], v[32:33], 0, s[64:65]
    v_and_b32 v232, v17, v4
    v_and_b32 v233, v17, v5
    v_and_b32 v234, v17, v6
    v_and_b32 v235, v17, v7
    v_and_b32 v236, v21, v4
    v_and_b32 v237, v21, v5
    v_and_b32 v238, v21, v6
    v_and_b32 v239, v21, v7
    s_waitcnt vmcnt(7)
    v_mfma_f32_16x16x32_bf16 v[8:11], v[232:235], v[68:71], v[8:11]
    v_mfma_f32_16x16x32_bf16 v[12:15], v[236:239], v[68:71], v[12:15]
    global_load_dwordx4 v[68:71], v[32:33], off
    v_lshl_add_u64 v[32:33], v[32:33], 0, s[64:65]
    v_and_b32 v224, v18, v4
    v_and_b32 v225, v18, v5
    v_and_b32 v226, v18, v6
    v_and_b32 v227, v18, v7
    v_and_b32 v228, v22, v4
    v_and_b32 v229, v22, v5
    v_and_b32 v230, v22, v6
    v_and_b32 v231, v22, v7
    s_waitcnt vmcnt(7)
    v_mfma_f32_16x16x32_bf16 v[8:11], v[224:227], v[72:75], v[8:11]
    v_mfma_f32_16x16x32_bf16 v[12:15], v[228:231], v[72:75], v[12:15]
    global_load_dwordx4 v[72:75], v[32:33], off
    v_lshl_add_u64 v[32:33], v[32:33], 0, s[64:65]
    v_and_b32 v232, v19, v4
    v_and_b32 v233, v19, v5
    v_and_b32 v234, v19, v6
    v_and_b32 v235, v19, v7
    v_and_b32 v236, v23, v4
    v_and_b32 v237, v23, v5
    v_and_b32 v238, v23, v6
    v_and_b32 v239, v23, v7
    s_waitcnt vmcnt(7)
    v_mfma_f32_16x16x32_bf16 v[8:11], v[232:235], v[76:79], v[8:11]
    v_mfma_f32_16x16x32_bf16 v[12:15], v[236:239], v[76:79], v[12:15]
    global_load_dwordx4 v[76:79], v[32:33], off
    v_lshl_add_u64 v[32:33], v[32:33], 0, s[64:65]
    v_and_b32 v224, v24, v4
    v_and_b32 v225, v24, v5
    v_and_b32 v226, v24, v6
    v_and_b32 v227, v24, v7
    v_and_b32 v228, v28, v4
    v_and_b32 v229, v28, v5
    v_and_b32 v230, v28, v6
    v_and_b32 v231, v28, v7
    s_waitcnt vmcnt(7)
    v_mfma_f32_16x16x32_bf16 v[8:11], v[224:227], v[80:83], v[8:11]
    v_mfma_f32_16x16x32_bf16 v[12:15], v[228:231], v[80:83], v[12:15]
    global_load_dwordx4 v[80:83], v[32:33], off
    v_lshl_add_u64 v[32:33], v[32:33], 0, s[64:65]
    v_and_b32 v232, v25, v4
    v_and_b32 v233, v25, v5
    v_and_b32 v234, v25, v6
    v_and_b32 v235, v25, v7
    v_and_b32 v236, v29, v4
    v_and_b32 v237, v29, v5
    v_and_b32 v238, v29, v6
    v_and_b32 v239, v29, v7
    s_waitcnt vmcnt(7)
    v_mfma_f32_16x16x32_bf16 v[8:11], v[232:235], v[84:87], v[8:11]
    v_mfma_f32_16x16x32_bf16 v[12:15], v[236:239], v[84:87], v[12:15]
    global_load_dwordx4 v[84:87], v[32:33], off
    v_lshl_add_u64 v[32:33], v[32:33], 0, s[64:65]
    v_and_b32 v224, v26, v4
    v_and_b32 v225, v26, v5
    v_and_b32 v226, v26, v6
    v_and_b32 v227, v26, v7
    v_and_b32 v228, v30, v4
    v_and_b32 v229, v30, v5
    v_and_b32 v230, v30, v6
    v_and_b32 v231, v30, v7
    s_waitcnt vmcnt(7)
    v_mfma_f32_16x16x32_bf16 v[8:11], v[224:227], v[88:91], v[8:11]
    v_mfma_f32_16x16x32_bf16 v[12:15], v[228:231], v[88:91], v[12:15]
    global_load_dwordx4 v[88:91], v[32:33], off
    v_lshl_add_u64 v[32:33], v[32:33], 0, s[64:65]
    v_and_b32 v232, v27, v4
    v_and_b32 v233, v27, v5
    v_and_b32 v234, v27, v6
    v_and_b32 v235, v27, v7
    v_and_b32 v236, v31, v4
    v_and_b32 v237, v31, v5
    v_and_b32 v238, v31, v6
    v_and_b32 v239, v31, v7
    s_waitcnt vmcnt(7)
    v_mfma_f32_16x16x32_bf16 v[8:11], v[232:235], v[92:95], v[8:11]
    v_mfma_f32_16x16x32_bf16 v[12:15], v[236:239], v[92:95], v[12:15]
    global_load_dwordx4 v[92:95], v[32:33], off
    v_lshl_add_u64 v[32:33], v[32:33], 0, s[64:65]
    s_sub_u32 s45, s45, 1
    s_cmp_lg_u32 s45, 0
    s_cbranch_scc1 L_gu
    ds_read_b128 v[16:19], v54 offset:5120
    ds_read_b128 v[20:23], v54 offset:9344
    ds_read_b128 v[24:27], v54 offset:5136
    ds_read_b128 v[28:31], v54 offset:9360
    v_add_u32 v54, 32, v54
    s_waitcnt lgkmcnt(0)
    v_and_b32 v224, v16, v4
    v_and_b32 v225, v16, v5
    v_and_b32 v226, v16, v6
    v_and_b32 v227, v16, v7
    v_and_b32 v228, v20, v4
    v_and_b32 v229, v20, v5
    v_and_b32 v230, v20, v6
    v_and_b32 v231, v20, v7
    s_waitcnt vmcnt(7)
    v_mfma_f32_16x16x32_bf16 v[8:11], v[224:227], v[64:67], v[8:11]
    v_mfma_f32_16x16x32_bf16 v[12:15], v[228:231], v[64:67], v[12:15]
    buffer_load_dwordx4 v[128:131], v49, s[56:59], s44 offen
    s_add_u32 s44, s44, 4096
    v_and_b32 v232, v17, v4
    v_and_b32 v233, v17, v5
    v_and_b32 v234, v17, v6
    v_and_b32 v235, v17, v7
    v_and_b32 v236, v21, v4
    v_and_b32 v237, v21, v5
    v_and_b32 v238, v21, v6
    v_and_b32 v239, v21, v7
    s_waitcnt vmcnt(7)
    v_mfma_f32_16x16x32_bf16 v[8:11], v[232:235], v[68:71], v[8:11]
    v_mfma_f32_16x16x32_bf16 v[12:15], v[236:239], v[68:71], v[12:15]
    buffer_load_dwordx4 v[132:135], v49, s[56:59], s44 offen
    s_add_u32 s44, s44, 4096
    v_and_b32 v224, v18, v4
    v_and_b32 v225, v18, v5
    v_and_b32 v226, v18, v6
    v_and_b32 v227, v18, v7
    v_and_b32 v228, v22, v4
    v_and_b32 v229, v22, v5
    v_and_b32 v230, v22, v6
    v_and_b32 v231, v22, v7
    s_waitcnt vmcnt(7)
    v_mfma_f32_16x16x32_bf16 v[8:11], v[224:227], v[72:75], v[8:11]
    v_mfma_f32_16x16x32_bf16 v[12:15], v[228:231], v[72:75], v[12:15]
    buffer_load_dwordx4 v[136:139], v49, s[56:59], s44 offen
    s_add_u32 s44, s44, 4096
    v_and_b32 v232, v19, v4
    v_and_b32 v233, v19, v5
    v_and_b32 v234, v19, v6
    v_and_b32 v235, v19, v7
    v_and_b32 v236, v23, v4
    v_and_b32 v237, v23, v5
    v_and_b32 v238, v23, v6
    v_and_b32 v239, v23, v7
    s_waitcnt vmcnt(7)
    v_mfma_f32_16x16x32_bf16 v[8:11], v[232:235], v[76:79], v[8:11]
    v_mfma_f32_16x16x32_bf16 v[12:15], v[236:239], v[76:79], v[12:15]
    buffer_load_dwordx4 v[140:143], v49, s[56:59], s44 offen
    s_add_u32 s44, s44, 4096
    v_and_b32 v224, v24, v4
    v_and_b32 v225, v24, v5
    v_and_b32 v226, v24, v6
    v_and_b32 v227, v24, v7
    v_and_b32 v228, v28, v4
    v_and_b32 v229, v28, v5
    v_and_b32 v230, v28, v6
    v_and_b32 v231, v28, v7
    s_waitcnt vmcnt(7)
    v_mfma_f32_16x16x32_bf16 v[8:11], v[224:227], v[80:83], v[8:11]
    v_mfma_f32_16x16x32_bf16 v[12:15], v[228:231], v[80:83], v[12:15]
    buffer_load_dwordx4 v[144:147], v49, s[56:59], s44 offen
    s_add_u32 s44, s44, 4096
    v_and_b32 v232, v25, v4
    v_and_b32 v233, v25, v5
    v_and_b32 v234, v25, v6
    v_and_b32 v235, v25, v7
    v_and_b32 v236, v29, v4
    v_and_b32 v237, v29, v5
    v_and_b32 v238, v29, v6
    v_and_b32 v239, v29, v7
    s_waitcnt vmcnt(7)
    v_mfma_f32_16x16x32_bf16 v[8:11], v[232:235], v[84:87], v[8:11]
    v_mfma_f32_16x16x32_bf16 v[12:15], v[236:239], v[84:87], v[12:15]
    buffer_load_dwordx4 v[148:151], v49, s[56:59], s44 offen
    s_add_u32 s44, s44, 4096
    v_and_b32 v224, v26, v4
    v_and_b32 v225, v26, v5
    v_and_b32 v226, v26, v6
    v_and_b32 v227, v26, v7
    v_and_b32 v228, v30, v4
    v_and_b32 v229, v30, v5
    v_and_b32 v230, v30, v6
    v_and_b32 v231, v30, v7
    s_waitcnt vmcnt(7)
    v_mfma_f32_16x16x32_bf16 v[8:11], v[224:227], v[88:91], v[8:11]
    v_mfma_f32_16x16x32_bf16 v[12:15], v[228:231], v[88:91], v[12:15]
    buffer_load_dwordx4 v[152:155], v49, s[56:59], s44 offen
    s_add_u32 s44, s44, 4096
    v_and_b32 v232, v27, v4
    v_and_b32 v233, v27, v5
    v_and_b32 v234, v27, v6
    v_and_b32 v235, v27, v7
    v_and_b32 v236, v31, v4
    v_and_b32 v237, v31, v5
    v_and_b32 v238, v31, v6
    v_and_b32 v239, v31, v7
    s_waitcnt vmcnt(7)
    v_mfma_f32_16x16x32_bf16 v[8:11], v[232:235], v[92:95], v[8:11]
    v_mfma_f32_16x16x32_bf16 v[12:15], v[236:239], v[92:95], v[12:15]
    buffer_load_dwordx4 v[156:159], v49, s[56:59], s44 offen
    s_add_u32 s44, s44, 4096
    s_nop 4
    v_cvt_pk_bf16_f32 v8, v8, v8
    v_and_b32 v8, 0xffff0000, v8
    v_cvt_pk_bf16_f32 v9, v9, v9
    v_and_b32 v9, 0xffff0000, v9
    v_cvt_pk_bf16_f32 v10, v10, v10
    v_and_b32 v10, 0xffff0000, v10
    v_cvt_pk_bf16_f32 v11, v11, v11
    v_and_b32 v11, 0xffff0000, v11
    v_cvt_pk_bf16_f32 v12, v12, v12
    v_and_b32 v12, 0xffff0000, v12
    v_cvt_pk_bf16_f32 v13, v13, v13
    v_and_b32 v13, 0xffff0000, v13
    v_cvt_pk_bf16_f32 v14, v14, v14
    v_and_b32 v14, 0xffff0000, v14
    v_cvt_pk_bf16_f32 v15, v15, v15
    v_and_b32 v15, 0xffff0000, v15
    v_max_f32 v16, 0, v8
    v_max_f32 v17, 0, v9
    v_max_f32 v18, 0, v10
    v_max_f32 v19, 0, v11
    v_max_f32 v20, 0, v12
    v_max_f32 v21, 0, v13
    v_max_f32 v22, 0, v14
    v_max_f32 v23, 0, v15
    v_mul_f32_dpp v16, v8, v16 row_ror:8 row_mask:0xf bank_mask:0xf
    v_mul_f32_dpp v17, v9, v17 row_ror:8 row_mask:0xf bank_mask:0xf
    v_mul_f32_dpp v18, v10, v18 row_ror:8 row_mask:0xf bank_mask:0xf
    v_mul_f32_dpp v19, v11, v19 row_ror:8 row_mask:0xf bank_mask:0xf
    v_mul_f32_dpp v20, v12, v20 row_ror:8 row_mask:0xf bank_mask:0xf
    v_mul_f32_dpp v21, v13, v21 row_ror:8 row_mask:0xf bank_mask:0xf
    v_mul_f32_dpp v22, v14, v22 row_ror:8 row_mask:0xf bank_mask:0xf
    v_mul_f32_dpp v23, v15, v23 row_ror:8 row_mask:0xf bank_mask:0xf
    v_cvt_pk_bf16_f32 v16, v16, v16
    v_cvt_pk_bf16_f32 v17, v17, v17
    v_cvt_pk_bf16_f32 v18, v18, v18
    v_cvt_pk_bf16_f32 v19, v19, v19
    v_cvt_pk_bf16_f32 v20, v20, v20
    v_cvt_pk_bf16_f32 v21, v21, v21
    v_cvt_pk_bf16_f32 v22, v22, v22
    v_cvt_pk_bf16_f32 v23, v23, v23
    v_lshrrev_b32 v52, 1, v51
    v_mul_u32_u24 v52, 80, v52
    v_and_b32 v53, 1, v51
    v_lshl_add_u32 v53, v50, 1, v53
    v_add_lshl_u32 v52, v52, v53, 2
    s_mov_b32 s46, 0x00ff00ff
    s_mov_b32 s47, 0x00ff00ff
    s_mov_b64 exec, s[46:47]
    ds_write_b32 v52, v16 offset:3840
    ds_write_b32 v52, v17 offset:3920
    ds_write_b32 v52, v18 offset:4000
    ds_write_b32 v52, v19 offset:4080
    ds_write_b32 v52, v20 offset:4480
    ds_write_b32 v52, v21 offset:4560
    ds_write_b32 v52, v22 offset:4640
    ds_write_b32 v52, v23 offset:4720
    s_mov_b64 exec, -1
    s_waitcnt lgkmcnt(0)
    ds_read_b128 v[192:195], v61 offset:3840
    ds_read_b128 v[196:199], v61 offset:3856
    ds_read_b128 v[200:203], v61 offset:3872
    ds_read_b128 v[204:207], v61 offset:3888
    ds_read_b128 v[208:211], v61 offset:4480
    ds_read_b128 v[212:215], v61 offset:4496
    ds_read_b128 v[216:219], v61 offset:4512
    ds_read_b128 v[220:223], v61 offset:4528
    s_waitcnt lgkmcnt(0)
    v_and_b32 v224, v192, v4
    v_and_b32 v225, v192, v5
    v_and_b32 v226, v192, v6
    v_and_b32 v227, v192, v7
    v_and_b32 v228, v208, v4
    v_and_b32 v229, v208, v5
    v_and_b32 v230, v208, v6
    v_and_b32 v231, v208, v7
    s_waitcnt vmcnt(7)
    buffer_load_dwordx4 v[160:163], v49, s[56:59], s44 offen
    s_add_u32 s44, s44, 4096
    v_mfma_f32_16x16x32_bf16 v[8:11], v[224:227], v[128:131], 0
    v_mfma_f32_16x16x32_bf16 v[12:15], v[228:231], v[128:131], 0
    v_and_b32 v232, v193, v4
    v_and_b32 v233, v193, v5
    v_and_b32 v234, v193, v6
    v_and_b32 v235, v193, v7
    v_and_b32 v236, v209, v4
    v_and_b32 v237, v209, v5
    v_and_b32 v238, v209, v6
    v_and_b32 v239, v209, v7
    s_waitcnt vmcnt(7)
    buffer_load_dwordx4 v[164:167], v49, s[56:59], s44 offen
    s_add_u32 s44, s44, 4096
    v_mfma_f32_16x16x32_bf16 v[8:11], v[232:235], v[132:135], v[8:11]
    v_mfma_f32_16x16x32_bf16 v[12:15], v[236:239], v[132:135], v[12:15]
    v_and_b32 v224, v194, v4
    v_and_b32 v225, v194, v5
    v_and_b32 v226, v194, v6
    v_and_b32 v227, v194, v7
    v_and_b32 v228, v210, v4
    v_and_b32 v229, v210, v5
    v_and_b32 v230, v210, v6
    v_and_b32 v231, v210, v7
    s_waitcnt vmcnt(7)
    buffer_load_dwordx4 v[168:171], v49, s[56:59], s44 offen
    s_add_u32 s44, s44, 4096
    v_mfma_f32_16x16x32_bf16 v[8:11], v[224:227], v[136:139], v[8:11]
    v_mfma_f32_16x16x32_bf16 v[12:15], v[228:231], v[136:139], v[12:15]
    v_and_b32 v232, v195, v4
    v_and_b32 v233, v195, v5
    v_and_b32 v234, v195, v6
    v_and_b32 v235, v195, v7
    v_and_b32 v236, v211, v4
    v_and_b32 v237, v211, v5
    v_and_b32 v238, v211, v6
    v_and_b32 v239, v211, v7
    s_waitcnt vmcnt(7)
    buffer_load_dwordx4 v[172:175], v49, s[56:59], s44 offen
    s_add_u32 s44, s44, 4096
    v_mfma_f32_16x16x32_bf16 v[8:11], v[232:235], v[140:143], v[8:11]
    v_mfma_f32_16x16x32_bf16 v[12:15], v[236:239], v[140:143], v[12:15]
    v_and_b32 v224, v196, v4
    v_and_b32 v225, v196, v5
    v_and_b32 v226, v196, v6
    v_and_b32 v227, v196, v7
    v_and_b32 v228, v212, v4
    v_and_b32 v229, v212, v5
    v_and_b32 v230, v212, v6
    v_and_b32 v231, v212, v7
    s_waitcnt vmcnt(7)
    buffer_load_dwordx4 v[176:179], v49, s[56:59], s44 offen
    s_add_u32 s44, s44, 4096
    v_mfma_f32_16x16x32_bf16 v[8:11], v[224:227], v[144:147], v[8:11]
    v_mfma_f32_16x16x32_bf16 v[12:15], v[228:231], v[144:147], v[12:15]
    v_and_b32 v232, v197, v4
    v_and_b32 v233, v197, v5
    v_and_b32 v234, v197, v6
    v_and_b32 v235, v197, v7
    v_and_b32 v236, v213, v4
    v_and_b32 v237, v213, v5
    v_and_b32 v238, v213, v6
    v_and_b32 v239, v213, v7
    s_waitcnt vmcnt(7)
    buffer_load_dwordx4 v[180:183], v49, s[56:59], s44 offen
    s_add_u32 s44, s44, 4096
    v_mfma_f32_16x16x32_bf16 v[8:11], v[232:235], v[148:151], v[8:11]
    v_mfma_f32_16x16x32_bf16 v[12:15], v[236:239], v[148:151], v[12:15]
    v_and_b32 v224, v198, v4
    v_and_b32 v225, v198, v5
    v_and_b32 v226, v198, v6
    v_and_b32 v227, v198, v7
    v_and_b32 v228, v214, v4
    v_and_b32 v229, v214, v5
    v_and_b32 v230, v214, v6
    v_and_b32 v231, v214, v7
    s_waitcnt vmcnt(7)
    buffer_load_dwordx4 v[184:187], v49, s[56:59], s44 offen
    s_add_u32 s44, s44, 4096
    v_mfma_f32_16x16x32_bf16 v[8:11], v[224:227], v[152:155], v[8:11]
    v_mfma_f32_16x16x32_bf16 v[12:15], v[228:231], v[152:155], v[12:15]
    v_and_b32 v232, v199, v4
    v_and_b32 v233, v199, v5
    v_and_b32 v234, v199, v6
    v_and_b32 v235, v199, v7
    v_and_b32 v236, v215, v4
    v_and_b32 v237, v215, v5
    v_and_b32 v238, v215, v6
    v_and_b32 v239, v215, v7
    s_waitcnt vmcnt(7)
    buffer_load_dwordx4 v[188:191], v49, s[56:59], s44 offen
    v_mfma_f32_16x16x32_bf16 v[8:11], v[232:235], v[156:159], v[8:11]
    v_mfma_f32_16x16x32_bf16 v[12:15], v[236:239], v[156:159], v[12:15]
    v_and_b32 v224, v200, v4
    v_and_b32 v225, v200, v5
    v_and_b32 v226, v200, v6
    v_and_b32 v227, v200, v7
    v_and_b32 v228, v216, v4
    v_and_b32 v229, v216, v5
    v_and_b32 v230, v216, v6
    v_and_b32 v231, v216, v7
    s_waitcnt vmcnt(7)
    v_mfma_f32_16x16x32_bf16 v[8:11], v[224:227], v[160:163], v[8:11]
    v_mfma_f32_16x16x32_bf16 v[12:15], v[228:231], v[160:163], v[12:15]
    v_and_b32 v232, v201, v4
    v_and_b32 v233, v201, v5
    v_and_b32 v234, v201, v6
    v_and_b32 v235, v201, v7
    v_and_b32 v236, v217, v4
    v_and_b32 v237, v217, v5
    v_and_b32 v238, v217, v6
    v_and_b32 v239, v217, v7
    s_waitcnt vmcnt(6)
    v_mfma_f32_16x16x32_bf16 v[8:11], v[232:235], v[164:167], v[8:11]
    v_mfma_f32_16x16x32_bf16 v[12:15], v[236:239], v[164:167], v[12:15]
    v_and_b32 v224, v202, v4
    v_and_b32 v225, v202, v5
    v_and_b32 v226, v202, v6
    v_and_b32 v227, v202, v7
    v_and_b32 v228, v218, v4
    v_and_b32 v229, v218, v5
    v_and_b32 v230, v218, v6
    v_and_b32 v231, v218, v7
    s_waitcnt vmcnt(5)
    v_mfma_f32_16x16x32_bf16 v[8:11], v[224:227], v[168:171], v[8:11]
    v_mfma_f32_16x16x32_bf16 v[12:15], v[228:231], v[168:171], v[12:15]
    v_and_b32 v232, v203, v4
    v_and_b32 v233, v203, v5
    v_and_b32 v234, v203, v6
    v_and_b32 v235, v203, v7
    v_and_b32 v236, v219, v4
    v_and_b32 v237, v219, v5
    v_and_b32 v238, v219, v6
    v_and_b32 v239, v219, v7
    s_waitcnt vmcnt(4)
    v_mfma_f32_16x16x32_bf16 v[8:11], v[232:235], v[172:175], v[8:11]
    v_mfma_f32_16x16x32_bf16 v[12:15], v[236:239], v[172:175], v[12:15]
    v_and_b32 v224, v204, v4
    v_and_b32 v225, v204, v5
    v_and_b32 v226, v204, v6
    v_and_b32 v227, v204, v7
    v_and_b32 v228, v220, v4
    v_and_b32 v229, v220, v5
    v_and_b32 v230, v220, v6
    v_and_b32 v231, v220, v7
    s_waitcnt vmcnt(3)
    v_mfma_f32_16x16x32_bf16 v[8:11], v[224:227], v[176:179], v[8:11]
    v_mfma_f32_16x16x32_bf16 v[12:15], v[228:231], v[176:179], v[12:15]
    v_and_b32 v232, v205, v4
    v_and_b32 v233, v205, v5
    v_and_b32 v234, v205, v6
    v_and_b32 v235, v205, v7
    v_and_b32 v236, v221, v4
    v_and_b32 v237, v221, v5
    v_and_b32 v238, v221, v6
    v_and_b32 v239, v221, v7
    s_waitcnt vmcnt(2)
    v_mfma_f32_16x16x32_bf16 v[8:11], v[232:235], v[180:183], v[8:11]
    v_mfma_f32_16x16x32_bf16 v[12:15], v[236:239], v[180:183], v[12:15]
    v_and_b32 v224, v206, v4
    v_and_b32 v225, v206, v5
    v_and_b32 v226, v206, v6
    v_and_b32 v227, v206, v7
    v_and_b32 v228, v222, v4
    v_and_b32 v229, v222, v5
    v_and_b32 v230, v222, v6
    v_and_b32 v231, v222, v7
    s_waitcnt vmcnt(1)
    v_mfma_f32_16x16x32_bf16 v[8:11], v[224:227], v[184:187], v[8:11]
    v_mfma_f32_16x16x32_bf16 v[12:15], v[228:231], v[184:187], v[12:15]
    v_and_b32 v232, v207, v4
    v_and_b32 v233, v207, v5
    v_and_b32 v234, v207, v6
    v_and_b32 v235, v207, v7
    v_and_b32 v236, v223, v4
    v_and_b32 v237, v223, v5
    v_and_b32 v238, v223, v6
    v_and_b32 v239, v223, v7
    s_waitcnt vmcnt(0)
    v_mfma_f32_16x16x32_bf16 v[8:11], v[232:235], v[188:191], v[8:11]
    v_mfma_f32_16x16x32_bf16 v[12:15], v[236:239], v[188:191], v[12:15]
    ds_write_b32 v63, v63 offset:3396
    s_mul_i32 s45, s69, 28
    s_add_u32 s45, s45, s68
    s_lshl_b32 s45, s45, 11
    s_add_u32 s69, s45, 524288
    s_nop 1
    v_and_or_b32 v32, v8, s71, v62
    v_and_or_b32 v33, v9, s71, v62
    v_and_or_b32 v34, v10, s71, v62
    v_and_or_b32 v35, v11, s71, v62
    v_and_or_b32 v36, v12, s71, v62
    v_and_or_b32 v37, v13, s71, v62
    v_and_or_b32 v38, v14, s71, v62
    v_and_or_b32 v39, v15, s71, v62
L_noffn:
    s_mov_b32 s40, s12
    s_mov_b32 s41, s13
    s_mov_b32 s42, 4194304
    s_mov_b32 s43, 0x20000
    s_lshl_b32 s44, s28, 17
    s_lshl_b32 s45, s3, 8
    s_add_u32 s44, s44, s45
    s_mov_b32 s64, 0x05040100
    s_mov_b32 s65, 0x07060302
    buffer_load_dwordx4 v[192:195], v1, s[40:43], s44 offen offset:0
    buffer_load_dwordx4 v[196:199], v1, s[40:43], s44 offen offset:1024
    s_waitcnt vmcnt(1)
    buffer_load_dwordx4 v[200:203], v1, s[40:43], s44 offen offset:2048
    s_waitcnt vmcnt(1)
    buffer_load_dwordx4 v[204:207], v1, s[40:43], s44 offen offset:3072
    s_add_u32 s44, s44, 0x1000
    s_waitcnt vmcnt(1)
    buffer_load_dwordx4 v[208:211], v1, s[40:43], s44 offen offset:0
    s_waitcnt vmcnt(1)
    buffer_load_dwordx4 v[212:215], v1, s[40:43], s44 offen offset:1024
    s_waitcnt vmcnt(1)
    buffer_load_dwordx4 v[216:219], v1, s[40:43], s44 offen offset:2048
    s_waitcnt vmcnt(1)
    buffer_load_dwordx4 v[220:223], v1, s[40:43], s44 offen offset:3072
    s_add_u32 s44, s44, 0x7000
    s_waitcnt vmcnt(1)
    buffer_load_dwordx4 v[224:227], v1, s[40:43], s44 offen offset:0
    s_waitcnt vmcnt(1)
    buffer_load_dwordx4 v[228:231], v1, s[40:43], s44 offen offset:1024
    v_perm_b32 v64, v196, v192, s64
    v_perm_b32 v65, v204, v200, s64
    v_perm_b32 v66, v212, v208, s64
    v_perm_b32 v67, v220, v216, s64
    v_perm_b32 v72, v196, v192, s65
    v_perm_b32 v73, v204, v200, s65
    v_perm_b32 v74, v212, v208, s65
    v_perm_b32 v75, v220, v216, s65
    v_perm_b32 v80, v197, v193, s64
    v_perm_b32 v81, v205, v201, s64
    v_perm_b32 v82, v213, v209, s64
    v_perm_b32 v83, v221, v217, s64
    v_perm_b32 v88, v197, v193, s65
    v_perm_b32 v89, v205, v201, s65
    v_perm_b32 v90, v213, v209, s65
    v_perm_b32 v91, v221, v217, s65
    v_perm_b32 v96, v198, v194, s64
    v_perm_b32 v97, v206, v202, s64
    v_perm_b32 v98, v214, v210, s64
    v_perm_b32 v99, v222, v218, s64
    v_perm_b32 v104, v198, v194, s65
    v_perm_b32 v105, v206, v202, s65
    v_perm_b32 v106, v214, v210, s65
    v_perm_b32 v107, v222, v218, s65
    v_perm_b32 v112, v199, v195, s64
    v_perm_b32 v113, v207, v203, s64
    v_perm_b32 v114, v215, v211, s64
    v_perm_b32 v115, v223, v219, s64
    v_perm_b32 v120, v199, v195, s65
    v_perm_b32 v121, v207, v203, s65
    v_perm_b32 v122, v215, v211, s65
    v_perm_b32 v123, v223, v219, s65
    s_waitcnt vmcnt(1)
    buffer_load_dwordx4 v[232:235], v1, s[40:43], s44 offen offset:2048
    s_waitcnt vmcnt(1)
    buffer_load_dwordx4 v[236:239], v1, s[40:43], s44 offen offset:3072
    s_add_u32 s44, s44, 0x1000
    s_waitcnt vmcnt(1)
    buffer_load_dwordx4 v[240:243], v1, s[40:43], s44 offen offset:0
    s_waitcnt vmcnt(1)
    buffer_load_dwordx4 v[244:247], v1, s[40:43], s44 offen offset:1024
    s_waitcnt vmcnt(1)
    buffer_load_dwordx4 v[248:251], v1, s[40:43], s44 offen offset:2048
    s_waitcnt vmcnt(1)
    buffer_load_dwordx4 v[252:255], v1, s[40:43], s44 offen offset:3072
    s_add_u32 s44, s44, 0x7000
    s_waitcnt vmcnt(1)
    buffer_load_dwordx4 v[192:195], v1, s[40:43], s44 offen offset:0
    s_waitcnt vmcnt(1)
    buffer_load_dwordx4 v[196:199], v1, s[40:43], s44 offen offset:1024
    v_perm_b32 v68, v228, v224, s64
    v_perm_b32 v69, v236, v232, s64
    v_perm_b32 v70, v244, v240, s64
    v_perm_b32 v71, v252, v248, s64
    v_perm_b32 v76, v228, v224, s65
    v_perm_b32 v77, v236, v232, s65
    v_perm_b32 v78, v244, v240, s65
    v_perm_b32 v79, v252, v248, s65
    v_perm_b32 v84, v229, v225, s64
    v_perm_b32 v85, v237, v233, s64
    v_perm_b32 v86, v245, v241, s64
    v_perm_b32 v87, v253, v249, s64
    v_perm_b32 v92, v229, v225, s65
    v_perm_b32 v93, v237, v233, s65
    v_perm_b32 v94, v245, v241, s65
    v_perm_b32 v95, v253, v249, s65
    v_perm_b32 v100, v230, v226, s64
    v_perm_b32 v101, v238, v234, s64
    v_perm_b32 v102, v246, v242, s64
    v_perm_b32 v103, v254, v250, s64
    v_perm_b32 v108, v230, v226, s65
    v_perm_b32 v109, v238, v234, s65
    v_perm_b32 v110, v246, v242, s65
    v_perm_b32 v111, v254, v250, s65
    v_perm_b32 v116, v231, v227, s64
    v_perm_b32 v117, v239, v235, s64
    v_perm_b32 v118, v247, v243, s64
    v_perm_b32 v119, v255, v251, s64
    v_perm_b32 v124, v231, v227, s65
    v_perm_b32 v125, v239, v235, s65
    v_perm_b32 v126, v247, v243, s65
    v_perm_b32 v127, v255, v251, s65
    s_waitcnt vmcnt(1)
    buffer_load_dwordx4 v[200:203], v1, s[40:43], s44 offen offset:2048
    s_waitcnt vmcnt(1)
    buffer_load_dwordx4 v[204:207], v1, s[40:43], s44 offen offset:3072
    s_add_u32 s44, s44, 0x1000
    s_waitcnt vmcnt(1)
    buffer_load_dwordx4 v[208:211], v1, s[40:43], s44 offen offset:0
    s_waitcnt vmcnt(1)
    buffer_load_dwordx4 v[212:215], v1, s[40:43], s44 offen offset:1024
    s_waitcnt vmcnt(1)
    buffer_load_dwordx4 v[216:219], v1, s[40:43], s44 offen offset:2048
    s_waitcnt vmcnt(1)
    buffer_load_dwordx4 v[220:223], v1, s[40:43], s44 offen offset:3072
    s_add_u32 s44, s44, 0x7000
    s_waitcnt vmcnt(1)
    buffer_load_dwordx4 v[224:227], v1, s[40:43], s44 offen offset:0
    s_waitcnt vmcnt(1)
    buffer_load_dwordx4 v[228:231], v1, s[40:43], s44 offen offset:1024
    v_perm_b32 v128, v196, v192, s64
    v_perm_b32 v129, v204, v200, s64
    v_perm_b32 v130, v212, v208, s64
    v_perm_b32 v131, v220, v216, s64
    v_perm_b32 v136, v196, v192, s65
    v_perm_b32 v137, v204, v200, s65
    v_perm_b32 v138, v212, v208, s65
    v_perm_b32 v139, v220, v216, s65
    v_perm_b32 v144, v197, v193, s64
    v_perm_b32 v145, v205, v201, s64
    v_perm_b32 v146, v213, v209, s64
    v_perm_b32 v147, v221, v217, s64
    v_perm_b32 v152, v197, v193, s65
    v_perm_b32 v153, v205, v201, s65
    v_perm_b32 v154, v213, v209, s65
    v_perm_b32 v155, v221, v217, s65
    v_perm_b32 v160, v198, v194, s64
    v_perm_b32 v161, v206, v202, s64
    v_perm_b32 v162, v214, v210, s64
    v_perm_b32 v163, v222, v218, s64
    v_perm_b32 v168, v198, v194, s65
    v_perm_b32 v169, v206, v202, s65
    v_perm_b32 v170, v214, v210, s65
    v_perm_b32 v171, v222, v218, s65
    v_perm_b32 v176, v199, v195, s64
    v_perm_b32 v177, v207, v203, s64
    v_perm_b32 v178, v215, v211, s64
    v_perm_b32 v179, v223, v219, s64
    v_perm_b32 v184, v199, v195, s65
    v_perm_b32 v185, v207, v203, s65
    v_perm_b32 v186, v215, v211, s65
    v_perm_b32 v187, v223, v219, s65
    s_waitcnt vmcnt(1)
    buffer_load_dwordx4 v[232:235], v1, s[40:43], s44 offen offset:2048
    s_waitcnt vmcnt(1)
    buffer_load_dwordx4 v[236:239], v1, s[40:43], s44 offen offset:3072
    s_add_u32 s44, s44, 0x1000
    s_waitcnt vmcnt(1)
    buffer_load_dwordx4 v[240:243], v1, s[40:43], s44 offen offset:0
    s_waitcnt vmcnt(1)
    buffer_load_dwordx4 v[244:247], v1, s[40:43], s44 offen offset:1024
    s_waitcnt vmcnt(1)
    buffer_load_dwordx4 v[248:251], v1, s[40:43], s44 offen offset:2048
    s_waitcnt vmcnt(1)
    buffer_load_dwordx4 v[252:255], v1, s[40:43], s44 offen offset:3072
    s_add_u32 s44, s44, 0x7000
    s_waitcnt vmcnt(0)
    v_perm_b32 v132, v228, v224, s64
    v_perm_b32 v133, v236, v232, s64
    v_perm_b32 v134, v244, v240, s64
    v_perm_b32 v135, v252, v248, s64
    v_perm_b32 v140, v228, v224, s65
    v_perm_b32 v141, v236, v232, s65
    v_perm_b32 v142, v244, v240, s65
    v_perm_b32 v143, v252, v248, s65
    v_perm_b32 v148, v229, v225, s64
    v_perm_b32 v149, v237, v233, s64
    v_perm_b32 v150, v245, v241, s64
    v_perm_b32 v151, v253, v249, s64
    v_perm_b32 v156, v229, v225, s65
    v_perm_b32 v157, v237, v233, s65
    v_perm_b32 v158, v245, v241, s65
    v_perm_b32 v159, v253, v249, s65
    v_perm_b32 v164, v230, v226, s64
    v_perm_b32 v165, v238, v234, s64
    v_perm_b32 v166, v246, v242, s64
    v_perm_b32 v167, v254, v250, s64
    v_perm_b32 v172, v230, v226, s65
    v_perm_b32 v173, v238, v234, s65
    v_perm_b32 v174, v246, v242, s65
    v_perm_b32 v175, v254, v250, s65
    v_perm_b32 v180, v231, v227, s64
    v_perm_b32 v181, v239, v235, s64
    v_perm_b32 v182, v247, v243, s64
    v_perm_b32 v183, v255, v251, s64
    v_perm_b32 v188, v231, v227, s65
    v_perm_b32 v189, v239, v235, s65
    v_perm_b32 v190, v247, v243, s65
    v_perm_b32 v191, v255, v251, s65
    s_cmp_eq_u32 s3, 1
    s_cbranch_scc1 L_h1end
    s_cmp_eq_u32 s3, 2
    s_cbranch_scc1 L_h2end
    s_cmp_eq_u32 s3, 3
    s_cbranch_scc1 L_stat
    s_cmp_lg_u32 s2, 0
    s_cbranch_scc1 L_fin
    s_mov_b32 s33, 1000000
L_pf0:
    ds_read_b32 v59, v63 offset:3392
    s_waitcnt lgkmcnt(0)
    v_cmp_eq_u32 vcc, 0xbf800000, v59
    s_cbranch_vccz L_pf0_ok
    s_sleep 16
    s_sub_u32 s33, s33, 1
    s_cmp_lg_u32 s33, 0
    s_cbranch_scc1 L_pf0
L_pf0_ok:
    v_lshlrev_b32 v52, 7, v0
    s_mov_b32 s44, 786432
    s_mov_b32 s45, 794624
    s_mov_b32 s46, 802816
    s_mov_b32 s47, 811008
    s_mov_b32 s33, 1000000
L_ep:
    buffer_load_dwordx4 v[16:19], v52, s[52:55], s44 offen sc1
    s_waitcnt vmcnt(0)
    buffer_load_dwordx4 v[20:23], v52, s[52:55], s45 offen sc1
    s_waitcnt vmcnt(0)
    buffer_load_dwordx4 v[24:27], v52, s[52:55], s46 offen sc1
    s_waitcnt vmcnt(0)
    buffer_load_dwordx4 v[28:31], v52, s[52:55], s47 offen sc1
    s_waitcnt vmcnt(0)
    v_xor_b32 v16, v16, v62
    v_xor_b32 v17, v17, v62
    v_xor_b32 v18, v18, v62
    v_xor_b32 v19, v19, v62
    v_xor_b32 v20, v20, v62
    v_xor_b32 v21, v21, v62
    v_xor_b32 v22, v22, v62
    v_xor_b32 v23, v23, v62
    v_xor_b32 v24, v24, v62
    v_xor_b32 v25, v25, v62
    v_xor_b32 v26, v26, v62
    v_xor_b32 v27, v27, v62
    v_xor_b32 v28, v28, v62
    v_xor_b32 v29, v29, v62
    v_xor_b32 v30, v30, v62
    v_xor_b32 v31, v31, v62
    v_or3_b32 v59, v16, v17, v18
    v_or3_b32 v59, v59, v19, v20
    v_or3_b32 v59, v59, v21, v22
    v_or3_b32 v59, v59, v23, v24
    v_or3_b32 v59, v59, v25, v26
    v_or3_b32 v59, v59, v27, v28
    v_or3_b32 v59, v59, v29, v30
    v_or_b32 v59, v59, v31
    v_and_b32 v59, 0xff, v59
    v_cmp_ne_u32 vcc, 0, v59
    s_cbranch_vccz L_ep_ok
    s_sleep 32
    s_sub_u32 s33, s33, 1
    s_cmp_lg_u32 s33, 0
    s_cbranch_scc1 L_ep
L_ep_ok:
    s_mov_b32 s44, 819200
    s_mov_b64 exec, 1
    buffer_store_dword v62, v63, s[52:55], s44 offen sc1
    s_mov_b64 exec, -1
    s_branch L_fin
L_h1end:
    s_cmp_eq_u32 s35, 0
    s_cbranch_scc1 L_fin
    s_mov_b32 s33, 1000000
L_p2:
    ds_read_b32 v59, v63 offset:3400
    s_waitcnt lgkmcnt(0)
    v_cmp_eq_u32 vcc, 0xbf800000, v59
    s_cbranch_vccz L_p2_ok
    s_sleep 4
    s_sub_u32 s33, s33, 1
    s_cmp_lg_u32 s33, 0
    s_cbranch_scc1 L_p2
L_p2_ok:
    buffer_store_dwordx4 v[32:35], v2, s[52:55], s69 offen offset:0 sc1
    buffer_store_dwordx4 v[36:39], v2, s[52:55], s69 offen offset:1024 sc1
    s_branch L_fin
L_h2end:
    s_branch L_fin
L_stat:
    s_mov_b32 s33, 1000000
L_pf3:
    ds_read_b32 v59, v63 offset:3392
    s_waitcnt lgkmcnt(0)
    v_cmp_eq_u32 vcc, 0xbf800000, v59
    s_cbranch_vccz L_pf3_ok
    s_sleep 16
    s_sub_u32 s33, s33, 1
    s_cmp_lg_u32 s33, 0
    s_cbranch_scc1 L_pf3
L_pf3_ok:
    s_mov_b32 s33, 1000000
L_mlp:
    buffer_load_dwordx4 v[28:31], v63, s[52:55], s69 offen sc1
    s_waitcnt vmcnt(0)
    v_xor_b32 v28, v28, v62
    v_xor_b32 v29, v29, v62
    v_xor_b32 v30, v30, v62
    v_xor_b32 v31, v31, v62
    v_or3_b32 v59, v28, v29, v30
    v_or_b32 v59, v59, v31
    v_and_b32 v59, 0xff, v59
    v_cmp_ne_u32 vcc, 0, v59
    s_cbranch_vccz L_mlp_ok
    s_sleep 32
    s_sub_u32 s33, s33, 1
    s_cmp_lg_u32 s33, 0
    s_cbranch_scc1 L_mlp
L_mlp_ok:
    v_max_f32 v22, v20, v28
    v_sub_f32 v20, v20, v22
    v_sub_f32 v28, v28, v22
    v_mul_f32 v20, 0x3fb8aa3b, v20
    v_mul_f32 v28, 0x3fb8aa3b, v28
    v_exp_f32 v20, v20
    v_exp_f32 v28, v28
    v_mul_f32 v21, v21, v20
    v_fmac_f32 v21, v29, v28
    v_rcp_f32 v21, v21
    v_mul_f32 v18, v18, v20
    v_mul_f32 v18, v18, v21
    ds_write_b32 v3, v18 offset:3584
L_fin:
    s_lshl_b32 s46, s31, 11
    s_lshl_b32 s47, s3, 9
    s_add_u32 s46, s46, s47
    v_bfe_u32 v53, v0, 2, 1
    v_mul_u32_u24 v52, 80, v3
    v_mul_u32_u24 v54, 160, v53
    v_add_u32 v52, v52, v54
    v_lshl_add_u32 v52, v51, 4, v52
    v_mul_u32_u24 v53, 0xaaaa, v53
    v_add_u32 v53, 0x4444, v53
    v_mov_b32 v192, 0
    v_mov_b32 v193, 0
    v_mov_b32 v194, 0
    v_mov_b32 v195, 0
    v_mov_b32 v196, 0
    v_mov_b32 v197, 0
    v_mov_b32 v198, 0
    v_mov_b32 v199, 0
    v_mov_b32 v200, 0
    v_mov_b32 v201, 0
    v_mov_b32 v202, 0
    v_mov_b32 v203, 0
    v_mov_b32 v204, 0
    v_mov_b32 v205, 0
    v_mov_b32 v206, 0
    v_mov_b32 v207, 0
    v_mov_b32 v208, 0
    v_mov_b32 v209, 0
    v_mov_b32 v210, 0
    v_mov_b32 v211, 0
    v_mov_b32 v212, 0
    v_mov_b32 v213, 0
    v_mov_b32 v214, 0
    v_mov_b32 v215, 0
    v_mov_b32 v216, 0
    v_mov_b32 v217, 0
    v_mov_b32 v218, 0
    v_mov_b32 v219, 0
    v_mov_b32 v220, 0
    v_mov_b32 v221, 0
    v_mov_b32 v222, 0
    v_mov_b32 v223, 0
    s_waitcnt lgkmcnt(0)
    s_barrier
    ds_read_b128 v[224:227], v52 offset:2048
    ds_read_b128 v[228:231], v52 offset:2112
    ds_read_b128 v[16:19], v63 offset:3584
    s_waitcnt lgkmcnt(2)
    v_smfmac_f32_16x16x64_bf16 v[192:195], v[224:227], v[64:71], v53
    s_waitcnt lgkmcnt(1)
    v_smfmac_f32_16x16x64_bf16 v[192:195], v[228:231], v[128:135], v53
    s_waitcnt lgkmcnt(0)
    v_smfmac_f32_16x16x64_bf16 v[208:211], v[224:227], v[96:103], v53
    v_smfmac_f32_16x16x64_bf16 v[208:211], v[228:231], v[160:167], v53
    v_smfmac_f32_16x16x64_bf16 v[196:199], v[224:227], v[72:79], v53
    v_smfmac_f32_16x16x64_bf16 v[196:199], v[228:231], v[136:143], v53
    v_smfmac_f32_16x16x64_bf16 v[212:215], v[224:227], v[104:111], v53
    s_nop 1
    v_mul_f32 v8, v192, v16
    v_fmac_f32 v8, v193, v17
    v_smfmac_f32_16x16x64_bf16 v[212:215], v[228:231], v[168:175], v53
    v_fmac_f32 v8, v194, v18
    v_fmac_f32 v8, v195, v19
    v_smfmac_f32_16x16x64_bf16 v[200:203], v[224:227], v[80:87], v53
    v_mul_f32 v12, v208, v16
    v_fmac_f32 v12, v209, v17
    v_smfmac_f32_16x16x64_bf16 v[200:203], v[228:231], v[144:151], v53
    v_fmac_f32 v12, v210, v18
    v_fmac_f32 v12, v211, v19
    v_smfmac_f32_16x16x64_bf16 v[216:219], v[224:227], v[112:119], v53
    v_mul_f32 v9, v196, v16
    v_fmac_f32 v9, v197, v17
    v_smfmac_f32_16x16x64_bf16 v[216:219], v[228:231], v[176:183], v53
    v_fmac_f32 v9, v198, v18
    v_fmac_f32 v9, v199, v19
    v_smfmac_f32_16x16x64_bf16 v[204:207], v[224:227], v[88:95], v53
    v_permlane16_swap_b32 v8, v12
    v_add_f32 v8, v8, v12
    v_smfmac_f32_16x16x64_bf16 v[204:207], v[228:231], v[152:159], v53
    v_and_or_b32 v8, v8, s71, v62
    v_mul_f32 v13, v212, v16
    v_smfmac_f32_16x16x64_bf16 v[220:223], v[224:227], v[120:127], v53
    v_fmac_f32 v13, v213, v17
    v_fmac_f32 v13, v214, v18
    v_smfmac_f32_16x16x64_bf16 v[220:223], v[228:231], v[184:191], v53
    v_fmac_f32 v13, v215, v19
    v_mul_f32 v10, v200, v16
    v_fmac_f32 v10, v201, v17
    v_fmac_f32 v10, v202, v18
    v_fmac_f32 v10, v203, v19
    v_permlane16_swap_b32 v9, v13
    v_add_f32 v9, v9, v13
    v_and_or_b32 v9, v9, s71, v62
    v_mul_f32 v14, v216, v16
    v_fmac_f32 v14, v217, v17
    v_fmac_f32 v14, v218, v18
    v_fmac_f32 v14, v219, v19
    v_mul_f32 v11, v204, v16
    v_fmac_f32 v11, v205, v17
    v_fmac_f32 v11, v206, v18
    v_fmac_f32 v11, v207, v19
    v_permlane16_swap_b32 v10, v14
    v_add_f32 v10, v10, v14
    v_and_or_b32 v10, v10, s71, v62
    v_mul_f32 v15, v220, v16
    v_fmac_f32 v15, v221, v17
    v_fmac_f32 v15, v222, v18
    v_fmac_f32 v15, v223, v19
    s_nop 1
    v_permlane16_swap_b32 v11, v15
    v_add_f32 v11, v11, v15
    v_and_or_b32 v11, v11, s71, v62
    s_mov_b32 exec_hi, 0
    buffer_store_dwordx4 v[8:11], v2, s[52:55], s46 offen sc1
L_end:
    s_endpgm
.section .rodata,"a"
.p2align 6
.amdhsa_kernel recurrent_scan__mha_block_cached__glu_gated_reglu__decode_kernel
  .amdhsa_next_free_vgpr 256
  .amdhsa_next_free_sgpr 96
  .amdhsa_accum_offset 256
  .amdhsa_group_segment_fixed_size 0
  .amdhsa_kernarg_size 96
  .amdhsa_user_sgpr_count 2
  .amdhsa_user_sgpr_kernarg_segment_ptr 1
  .amdhsa_system_sgpr_workgroup_id_x 1
.end_amdhsa_kernel
```
